```python
import torch

def _softmax(x, axis=-1):
    return torch.softmax(x, dim=axis)
def _gelu(x):
    return torch.nn.functional.gelu(x, approximate="tanh")
def _silu(x):
    return torch.nn.functional.silu(x)
def _sigmoid(x):
    return torch.sigmoid(x)
def _layernorm(x, axis=-1, eps=1e-5):
    m = x.mean(dim=axis, keepdim=True)
    v = x.var(dim=axis, keepdim=True, unbiased=False)
    return (x - m) / torch.sqrt(v + eps)
def _scatter_add(tgt, idx, src, axis=0):
    return tgt.clone().index_add_(axis, idx, src)
def _segment_sum(src, seg, n):
    out = torch.zeros((n,) + src.shape[1:], dtype=src.dtype)
    return out.index_add_(0, seg, src)
def _pad(x, pw):
    flat = tuple(v for pair in reversed(pw) for v in pair)
    return torch.nn.functional.pad(x, flat)

kernel_name = 'parallel_sum__ssm_conv_s4__geglu_ffn__prompt'

def setup_inputs():

    _w = (lambda a: (lambda t: t.to(torch.bfloat16) if t.is_floating_point() else t)(torch.as_tensor(a)))
    def _A_setup():
        B, L, D, N = 1, 2048, 512, 128
        A_re = -(lambda _x: torch.exp(torch.as_tensor(_x)))((lambda *s: torch.randn(*s, dtype=torch.bfloat16) * 3.2)(D, N))
        A_im = torch.pi * (lambda *s: torch.randn(*s, dtype=torch.bfloat16) * 0.2)(D, N)
        B_re = (lambda *s: torch.randn(*s, dtype=torch.bfloat16) * 0.4)(D, N)
        B_im = (lambda *s: torch.randn(*s, dtype=torch.bfloat16) * 0.4)(D, N)
        C_re = (lambda *s: torch.randn(*s, dtype=torch.bfloat16) * 0.4)(D, N)
        C_im = (lambda *s: torch.randn(*s, dtype=torch.bfloat16) * 0.4)(D, N)
        log_dt = (lambda *s: torch.randn(*s, dtype=torch.bfloat16) * 0.2)(D) * 0.5 - 4.0
        Dskip = (lambda *s: torch.randn(*s, dtype=torch.bfloat16) * 0.4)(D)
        return {
            "u": _w((lambda *s: torch.randn(*s, dtype=torch.bfloat16) * 0.05)(B, L, D)),
            "A_re": _w(A_re),
            "A_im": _w(A_im),
            "B_re": _w(B_re),
            "B_im": _w(B_im),
            "C_re": _w(C_re),
            "C_im": _w(C_im),
            "log_dt": _w(log_dt),
            "Dskip": _w(Dskip),
        }
    _A_in = _A_setup()

    def _B_setup():
        B, S, D, F = 1, 2048, 512, 1792
        return {
            "x": _w((lambda *s: torch.randn(*s, dtype=torch.bfloat16) * 0.05)(B, S, D)),
            "w_gate": _w((lambda *s: torch.randn(*s, dtype=torch.bfloat16) * 0.05)(D, F)),
            "w_up": _w((lambda *s: torch.randn(*s, dtype=torch.bfloat16) * 0.05)(D, F)),
            "w_down": _w((lambda *s: torch.randn(*s, dtype=torch.bfloat16) * 0.05)(F, D)),
        }
    _B_in = _B_setup()

    return {
        "A_u": _A_in["u"],
        "A_A_re": _A_in["A_re"],
        "A_A_im": _A_in["A_im"],
        "A_B_re": _A_in["B_re"],
        "A_B_im": _A_in["B_im"],
        "A_C_re": _A_in["C_re"],
        "A_C_im": _A_in["C_im"],
        "A_log_dt": _A_in["log_dt"],
        "A_Dskip": _A_in["Dskip"],
        "B_x": _B_in["x"],
        "B_w_gate": _B_in["w_gate"],
        "B_w_up": _B_in["w_up"],
        "B_w_down": _B_in["w_down"],
    }

def reference(A_u, A_A_re, A_A_im, A_B_re, A_B_im, A_C_re, A_C_im, A_log_dt, A_Dskip, B_x, B_w_gate, B_w_up, B_w_down):
    def _A_ref(u, A_re, A_im, B_re, B_im, C_re, C_im, log_dt, Dskip):
        Bsz, L, D = u.shape
        dt = torch.exp(log_dt)[:, None]
        A = A_re + 1j * A_im
        Bc = B_re + 1j * B_im
        Cc = C_re + 1j * C_im
        logdA = dt * A
        dB = dt * Bc
        l = (lambda x, dt: x.to(dt))(torch.arange(L), A_re.dtype)
        P = torch.exp(logdA[:, :, None] * l[None, None, :])
        K = torch.einsum("dn,dnl,dn->dl", Cc, P, dB).real
        L2 = 2 * L
        Kp = _pad(K, ((0, 0), (0, L)))
        up = (lambda x, *d: x.permute(*d))(u, 0, 2, 1)
        up = _pad(up, ((0, 0), (0, 0), (0, L)))
        Kf = (lambda x, axes=(-2,-1): torch.fft.rfft2(x.float(), dim=axes))(Kp[:, None, :], axes=(-2, -1))
        Uf = (lambda x, axes=(-2,-1): torch.fft.rfft2(x.float(), dim=axes))(up[:, :, None, :], axes=(-2, -1))
        Yf = Uf * Kf[None, :, :, :]
        y = (lambda x, s, axes=(-2,-1): torch.fft.irfft2(x, s=s, dim=axes).to(torch.bfloat16))(Yf, (1, L2), axes=(-2, -1))[:, :, 0, :L]
        y = (lambda x, *d: x.permute(*d))(y, 0, 2, 1) + u * Dskip[None, None, :]
        return y

    def _B_ref(x, w_gate, w_up, w_down):
        return (_gelu(x @ w_gate) * (x @ w_up)) @ w_down

    x = A_u
    xn = _layernorm(x, axis=-1)
    return x + _A_ref(xn, A_A_re, A_A_im, A_B_re, A_B_im, A_C_re, A_C_im, A_log_dt, A_Dskip) + _B_ref(xn, B_w_gate, B_w_up, B_w_down)
```

```asm
; @launch grid=(256,1,1) block=(512,1,1) lds=163840
.amdgcn_target "amdgcn-amd-amdhsa--gfx950"
.text
.globl parallel_sum__ssm_conv_s4__geglu_ffn__prompt_kernel
.p2align 8
.type parallel_sum__ssm_conv_s4__geglu_ffn__prompt_kernel,@function
parallel_sum__ssm_conv_s4__geglu_ffn__prompt_kernel:
    s_load_dwordx16 s[16:31], s[0:1], 0
    s_load_dwordx16 s[32:47], s[0:1], 64
    s_cmp_ge_u32 s2, 256
    s_cbranch_scc1 parallel_sum__ssm_conv_s4__geglu_ffn__prompt_kernel_end
    s_getpc_b64 s[98:99]
parallel_sum__ssm_conv_s4__geglu_ffn__prompt_kernel_pc:
    v_lshrrev_b32 v1, 6, v0
    v_lshlrev_b32 v40, 4, v0
    v_and_b32 v40, 0xff0, v40
    v_add_u32 v40, parallel_sum__ssm_conv_s4__geglu_ffn__prompt_kernel_tab-parallel_sum__ssm_conv_s4__geglu_ffn__prompt_kernel_pc, v40
    global_load_dwordx4 v[40:43], v40, s[98:99]
    v_and_b32 v0, 63, v0
    v_readfirstlane_b32 s101, v1
    s_andn2_b32 s3, s2, 7
    v_add_u32 v250, s3, v1
    v_and_b32 v1, 1, v0
    v_lshl_add_u32 v250, v1, 8, v250
    v_lshlrev_b32 v250, 7, v250
    v_min_u32 v250, parallel_sum__ssm_conv_s4__geglu_ffn__prompt_kernel_fin-parallel_sum__ssm_conv_s4__geglu_ffn__prompt_kernel_pc-4, v250
    global_load_dword v251, v250, s[98:99]
    s_and_b32 s96, s2, 7
    s_lshr_b32 s97, s2, 3
    s_lshl_b32 s50, s96, 5
    s_add_u32 s50, s50, s97
    s_lshl_b32 s54, s101, 11
    s_lshl_b32 s55, s101, 10
    s_and_b32 s69, s101, 1
    s_lshl_b32 s3, s50, 1
    s_add_u32 s3, s3, s69
    s_lshl_b32 s3, s3, 8
    s_and_b32 s69, s101, 2
    s_lshl_b32 s69, s69, 6
    s_add_u32 s3, s3, s69
    v_lshl_add_u32 v14, v0, 1, s3
    v_lshlrev_b32 v2, 4, v0
    v_lshrrev_b32 v8, 3, v0
    v_and_b32 v9, 0x70, v2
    v_mov_b32 v31, 0
    v_mov_b32 v208, 0
    v_mov_b32 v209, 0
    v_mov_b32 v210, 0
    v_mov_b32 v211, 0
    v_mov_b32 v212, 0
    v_mov_b32 v213, 0
    s_sub_u32 s95, s97, 4
    s_and_b32 s68, s96, 3
    s_lshl_b32 s48, s68, 2
    s_and_b32 s3, s95, 3
    s_add_u32 s48, s48, s3
    s_lshr_b32 s49, s96, 2
    s_mul_i32 s49, s49, 7
    s_lshr_b32 s3, s95, 2
    s_add_u32 s49, s49, s3
    s_lshl_b32 s53, s48, 3
    s_add_u32 s53, s53, s101
    s_lshl_b32 s53, s53, 14
    s_mul_i32 s66, s101, 28672
    s_lshl_b32 s3, s49, 7
    s_add_u32 s64, s66, s3
    v_mul_u32_u24 v6, 3584, v8
    v_add_u32 v6, v6, v9
    v_and_b32 v7, 16, v0
    v_lshlrev_b32 v7, 1, v7
    v_xor_b32 v12, v6, v7
    v_xor_b32 v13, 64, v12
    v_and_b32 v7, 48, v0
    v_xor_b32 v4, v9, v7
    v_lshl_or_b32 v4, v8, 10, v4
    v_xor_b32 v5, 64, v4
    v_add_u32 v5, 7168, v5
    s_waitcnt lgkmcnt(0)
    s_mov_b32 s56, s46
    s_mov_b32 s57, s47
    s_mov_b32 s58, 0x1100000
    s_mov_b32 s59, 0x00020000
    s_load_dword s100, s[46:47], 0xa0000
    s_mov_b32 s4, s16
    s_mov_b32 s5, s17
    s_mov_b32 s6, 0x200000
    s_mov_b32 s7, 0x00020000
    s_cmp_lt_u32 s97, 4
    s_cbranch_scc1 Lrole
    global_load_short_d16_hi v208, v14, s[18:19]
    global_load_short_d16_hi v209, v14, s[20:21]
    s_cmp_lt_u32 s101, 4
    s_cbranch_scc1 Lo_15
    global_load_short_d16_hi v210, v14, s[22:23]
    global_load_short_d16_hi v211, v14, s[24:25]
    global_load_short_d16_hi v212, v14, s[26:27]
    global_load_short_d16_hi v213, v14, s[28:29]
Lo_15:
    s_lshl_b32 s3, s50, 2
    s_load_dword s92, s[30:31], s3
    s_load_dword s93, s[32:33], s3
    s_mov_b32 s8, s36
    s_mov_b32 s9, s37
    s_mov_b32 s10, 0x1c0000
    s_mov_b32 s11, 0x00020000
    s_mov_b32 s12, s38
    s_mov_b32 s13, s39
    s_mov_b32 s14, 0x1c0000
    s_mov_b32 s15, 0x00020000
    s_add_u32 s44, s95, s49
    s_lshl_b32 s44, s44, 2
    s_andn2_b32 s3, 1, s96
    s_lshl1_add_u32 s44, s3, s44
    s_add_u32 m0, s54, 32768
    s_add_u32 s34, s44, 0
    s_and_b32 s34, s34, 7
    s_mul_i32 s34, s34, 128
    s_add_u32 s34, s34, s53
    buffer_load_dwordx4 v4, s[4:7], s34 offen lds
    buffer_load_dwordx4 v5, s[4:7], s34 offen offset:1024 lds
    s_add_u32 m0, s55, 81920
    s_add_u32 s34, s44, 0
    s_and_b32 s34, s34, 7
    s_mul_i32 s34, s34, 229376
    s_add_u32 s34, s34, s64
    buffer_load_dwordx4 v12, s[8:11], s34 offen lds
    s_add_u32 m0, s55, 90112
    s_nop 0
    buffer_load_dwordx4 v13, s[12:15], s34 offen lds
    s_mov_b32 s16, s40
    s_mov_b32 s17, s41
    s_mov_b32 s18, 0x1c0000
    s_mov_b32 s19, 0x00020000
    v_lshl_or_b32 v69, v8, 10, v9
    s_lshl3_add_u32 s40, s95, s101
    s_lshl_b32 s40, s40, 6
    s_add_u32 s40, s40, s96
    s_lshl_b32 s40, s40, 7
    s_mul_i32 s41, s96, 28
    s_add_u32 s41, s41, s95
    s_lshl_b32 s41, s41, 13
    s_add_u32 s41, s41, s55
    s_add_u32 s41, s41, 0xe00000
    s_add_u32 m0, s55, 155328
    s_nop 0
    buffer_load_dwordx4 v69, s[16:19], s40 offen lds
    s_bitcmp1_b32 s95, 0
    s_cselect_b32 s60, s38, s36
    s_cselect_b32 s61, s39, s37
    s_mov_b32 s62, 1835008
    s_mov_b32 s63, 0x00020000
    s_bfe_u32 s69, s95, 0x10001
    s_mul_i32 s45, s69, 1792
    s_mul_i32 s3, s68, 458752
    s_add_u32 s45, s45, s3
    s_add_u32 s45, s45, s64
    s_add_u32 s45, s45, s66
    s_add_u32 s51, s96, 1
    s_and_b32 s51, s51, 3
    s_lshl_b32 s51, s51, 3
    s_and_b32 s3, s96, 4
    s_add_u32 s51, s51, s3
    s_and_b32 s3, s97, 3
    s_add_u32 s51, s51, s3
    s_lshr_b32 s52, s97, 2
    s_lshr_b32 s67, s101, 2
    s_and_b32 s90, s101, 3
    s_lshl_b32 s65, s52, 4
    s_add_u32 s65, s65, s101
    s_mul_i32 s65, s65, 14336
    s_add_u32 s65, s65, 14680064
    v_and_b32 v26, 16, v0
    v_lshrrev_b32 v27, 5, v0
    v_bfe_u32 v23, v0, 2, 2
    v_lshl_add_u32 v24, v27, 3, v23
    v_lshlrev_b32 v25, 4, v1
    v_and_b32 v23, 2, v0
    v_lshl_or_b32 v25, v23, 2, v25
    s_lshl_b32 s36, s49, 13
    s_add_u32 s36, s36, 65536
    s_lshl_b32 s66, s69, 2
    s_lshr_b32 s3, s68, 1
    s_add_u32 s66, s66, s3
    s_and_b32 s3, s95, 1
    s_lshl1_add_u32 s66, s66, s3
    s_lshl_b32 s66, s66, 5
    s_and_b32 s3, s68, 1
    s_add_u32 s66, s66, s3
    s_lshl3_add_u32 s66, s66, s36
    s_mov_b32 s95, 0
    s_and_b32 s68, s101, 1
    s_bfe_u32 s69, s101, 0x10001
    s_mul_i32 s94, s68, 28512
    s_add_u32 s94, s94, 98304
    v_and_b32 v38, 15, v0
    v_mul_u32_u24 v33, 528, v38
    v_and_b32 v39, 16, v0
    v_lshl_add_u32 v33, v39, 4, v33
    v_and_b32 v39, 32, v0
    v_lshl_add_u32 v33, v39, 2, v33
    s_mul_i32 s3, s69, 8448
    s_add_u32 s3, s3, s94
    v_add_u32 v32, s3, v33
    s_mul_i32 s3, s67, 8448
    s_add_u32 s3, s3, s94
    s_add_u32 s3, s3, 11616
    v_add_u32 v33, s3, v33
    v_lshl_or_b32 v16, v26, 9, v25
    v_lshl_or_b32 v16, v24, 7, v16
    v_and_b32 v28, 24, v0
    v_lshl_or_b32 v16, v28, 2, v16
    s_lshl_b32 s3, s67, 6
    v_xor_b32 v16, s3, v16
    v_xor_b32 v17, 32, v16
    v_add_u32 v14, 49152, v16
    v_add_u32 v15, 49152, v17
    v_bfe_u32 v28, v0, 1, 3
    v_xor_b32 v28, v28, v27
    v_and_b32 v8, 31, v0
    v_lshlrev_b32 v19, 3, v8
    v_lshlrev_b32 v8, 7, v8
    v_lshl_or_b32 v8, v28, 4, v8
    s_lshl_b32 s3, s90, 12
    v_or_b32 v8, s3, v8
    v_xor_b32 v9, 32, v8
    v_xor_b32 v10, 64, v8
    v_xor_b32 v11, 0x60, v8
    v_and_b32 v68, 3, v0
    v_lshlrev_b32 v68, 3, v68
    v_lshl_or_b32 v68, v24, 7, v68
    v_lshl_or_b32 v68, v26, 1, v68
    s_lshl_b32 s3, s101, 6
    s_and_b32 s3, s3, 64
    s_andn2_b32 s98, s55, 1024
    s_add_u32 s3, s3, s98
    s_add_u32 s3, s3, 155328
    v_add_u32 v68, s3, v68
    v_and_b32 v92, 16, v2
    v_mov_b32 v93, 0x3f80
    v_lshlrev_b32 v92, v92, v93
    v_bfe_u32 v93, v0, 1, 2
    v_cmp_eq_u32 vcc, 0, v93
    v_cmp_eq_u32 s[98:99], 1, v93
    s_nop 0
    v_cndmask_b32 v88, 0, v92, vcc
    v_cndmask_b32 v89, 0, v92, s[98:99]
    v_cmp_eq_u32 vcc, 2, v93
    v_cmp_eq_u32 s[98:99], 3, v93
    s_nop 0
    v_cndmask_b32 v90, 0, v92, vcc
    v_cndmask_b32 v91, 0, v92, s[98:99]
    v_and_b32 v20, 15, v0
    v_lshl_or_b32 v20, v20, 5, v26
    s_lshl_b32 s3, s101, 9
    s_add_u32 s3, s3, 146304
    v_add_u32 v20, s3, v20
    s_lshl_b32 s3, s68, 4
    s_waitcnt lgkmcnt(0)
    s_lshr_b32 s92, s92, s3
    s_lshl_b32 s92, s92, 16
    v_mov_b32 v214, 0x3fb8aa00
    v_mov_b32 v215, 0x36eca570
    v_mul_f32 v214, s92, v214
    v_mul_f32 v215, s92, v215
    v_exp_f32 v214, v214
    v_exp_f32 v215, v215
    s_lshl_b32 s3, s69, 8
    s_add_u32 s3, s3, s94
    v_lshl_add_u32 v1, v0, 2, s3
    v_mul_f32 v214, v214, v215
    v_cvt_pk_bf16_f32 v214, v214, v214
    v_and_b32 v214, 0xffff0000, v214
    s_waitcnt vmcnt(6)
    v_mul_f32 v208, v214, v208
    s_waitcnt vmcnt(5)
    v_mul_f32 v209, v214, v209
    s_cmp_ge_u32 s101, 4
    s_cbranch_scc1 Gk1
    v_mul_f32 v220, 0x4138aa3b, v208
    v_mul_f32 v221, 0x3fa2f983, v209
    v_exp_f32 v220, v220
    v_fract_f32 v221, v221
    v_cos_f32 v226, v221
    v_sin_f32 v227, v221
    v_mul_f32 v226, v226, v220
    v_mul_f32 v227, v227, v220
    v_mov_b32 v216, 0x3f80
    ds_write_b32 v1, v216 offset:11616
    v_pk_mul_f32 v[228:229], v[226:227], v[226:227] op_sel:[0,0] op_sel_hi:[1,0]
    v_pk_fma_f32 v[228:229], v[226:227], v[226:227], v[228:229] op_sel:[1,1,0] op_sel_hi:[0,1,1] neg_lo:[1,0,0]
    v_cvt_pk_bf16_f32 v217, v226, v227
    ds_write_b32 v1, v217 offset:12144
    v_pk_mul_f32 v[230:231], v[228:229], v[226:227] op_sel:[0,0] op_sel_hi:[1,0]
    v_pk_fma_f32 v[230:231], v[228:229], v[226:227], v[230:231] op_sel:[1,1,0] op_sel_hi:[0,1,1] neg_lo:[1,0,0]
    v_pk_mul_f32 v[222:223], v[228:229], v[228:229] op_sel:[0,0] op_sel_hi:[1,0]
    v_pk_fma_f32 v[222:223], v[228:229], v[228:229], v[222:223] op_sel:[1,1,0] op_sel_hi:[0,1,1] neg_lo:[1,0,0]
    v_cvt_pk_bf16_f32 v218, v228, v229
    ds_write_b32 v1, v218 offset:12672
    v_cvt_pk_bf16_f32 v219, v230, v231
    ds_write_b32 v1, v219 offset:13200
    v_cvt_pk_bf16_f32 v216, v222, v223
    ds_write_b32 v1, v216 offset:13728
    v_pk_mul_f32 v[234:235], v[226:227], v[222:223] op_sel:[0,0] op_sel_hi:[1,0]
    v_pk_fma_f32 v[234:235], v[226:227], v[222:223], v[234:235] op_sel:[1,1,0] op_sel_hi:[0,1,1] neg_lo:[1,0,0]
    v_pk_mul_f32 v[236:237], v[228:229], v[222:223] op_sel:[0,0] op_sel_hi:[1,0]
    v_pk_fma_f32 v[236:237], v[228:229], v[222:223], v[236:237] op_sel:[1,1,0] op_sel_hi:[0,1,1] neg_lo:[1,0,0]
    v_cvt_pk_bf16_f32 v217, v234, v235
    ds_write_b32 v1, v217 offset:14256
    v_pk_mul_f32 v[238:239], v[230:231], v[222:223] op_sel:[0,0] op_sel_hi:[1,0]
    v_pk_fma_f32 v[238:239], v[230:231], v[222:223], v[238:239] op_sel:[1,1,0] op_sel_hi:[0,1,1] neg_lo:[1,0,0]
    v_cvt_pk_bf16_f32 v218, v236, v237
    s_cmp_lg_u32 s101, 3
    s_cbranch_scc1 Lo_16
    v_min_u32 v70, 19, v0
    v_lshlrev_b32 v70, 7, v70
    s_sub_u32 s3, s2, 32
    s_mul_i32 s3, s3, 2560
    s_add_u32 s3, s3, 0
    buffer_load_dword v70, v70, s[56:59], s3 offen
Lo_16:
    ds_write_b32 v1, v218 offset:14784
    v_pk_mul_f32 v[224:225], v[222:223], v[222:223] op_sel:[0,0] op_sel_hi:[1,0]
    v_pk_fma_f32 v[224:225], v[222:223], v[222:223], v[224:225] op_sel:[1,1,0] op_sel_hi:[0,1,1] neg_lo:[1,0,0]
    v_cvt_pk_bf16_f32 v219, v238, v239
    ds_write_b32 v1, v219 offset:15312
    v_pk_mul_f32 v[226:227], v[234:235], v[222:223] op_sel:[0,0] op_sel_hi:[1,0]
    v_pk_fma_f32 v[226:227], v[234:235], v[222:223], v[226:227] op_sel:[1,1,0] op_sel_hi:[0,1,1] neg_lo:[1,0,0]
    v_cvt_pk_bf16_f32 v216, v224, v225
    ds_write_b32 v1, v216 offset:15840
    v_pk_mul_f32 v[228:229], v[236:237], v[222:223] op_sel:[0,0] op_sel_hi:[1,0]
    v_pk_fma_f32 v[228:229], v[236:237], v[222:223], v[228:229] op_sel:[1,1,0] op_sel_hi:[0,1,1] neg_lo:[1,0,0]
    v_cvt_pk_bf16_f32 v217, v226, v227
    ds_write_b32 v1, v217 offset:16368
    v_pk_mul_f32 v[230:231], v[238:239], v[222:223] op_sel:[0,0] op_sel_hi:[1,0]
    v_pk_fma_f32 v[230:231], v[238:239], v[222:223], v[230:231] op_sel:[1,1,0] op_sel_hi:[0,1,1] neg_lo:[1,0,0]
    v_cvt_pk_bf16_f32 v218, v228, v229
    ds_write_b32 v1, v218 offset:16896
    v_pk_mul_f32 v[232:233], v[224:225], v[222:223] op_sel:[0,0] op_sel_hi:[1,0]
    v_pk_fma_f32 v[232:233], v[224:225], v[222:223], v[232:233] op_sel:[1,1,0] op_sel_hi:[0,1,1] neg_lo:[1,0,0]
    v_cvt_pk_bf16_f32 v219, v230, v231
    ds_write_b32 v1, v219 offset:17424
    v_pk_mul_f32 v[234:235], v[226:227], v[222:223] op_sel:[0,0] op_sel_hi:[1,0]
    v_pk_fma_f32 v[234:235], v[226:227], v[222:223], v[234:235] op_sel:[1,1,0] op_sel_hi:[0,1,1] neg_lo:[1,0,0]
    v_cvt_pk_bf16_f32 v216, v232, v233
    ds_write_b32 v1, v216 offset:17952
    v_pk_mul_f32 v[236:237], v[228:229], v[222:223] op_sel:[0,0] op_sel_hi:[1,0]
    v_pk_fma_f32 v[236:237], v[228:229], v[222:223], v[236:237] op_sel:[1,1,0] op_sel_hi:[0,1,1] neg_lo:[1,0,0]
    v_cvt_pk_bf16_f32 v217, v234, v235
    ds_write_b32 v1, v217 offset:18480
    v_pk_mul_f32 v[238:239], v[230:231], v[222:223] op_sel:[0,0] op_sel_hi:[1,0]
    v_pk_fma_f32 v[238:239], v[230:231], v[222:223], v[238:239] op_sel:[1,1,0] op_sel_hi:[0,1,1] neg_lo:[1,0,0]
    v_cvt_pk_bf16_f32 v218, v236, v237
    ds_write_b32 v1, v218 offset:19008
    v_pk_mul_f32 v[224:225], v[232:233], v[222:223] op_sel:[0,0] op_sel_hi:[1,0]
    v_pk_fma_f32 v[224:225], v[232:233], v[222:223], v[224:225] op_sel:[1,1,0] op_sel_hi:[0,1,1] neg_lo:[1,0,0]
    v_cvt_pk_bf16_f32 v219, v238, v239
    ds_write_b32 v1, v219 offset:19536
    v_pk_mul_f32 v[226:227], v[234:235], v[222:223] op_sel:[0,0] op_sel_hi:[1,0]
    v_pk_fma_f32 v[226:227], v[234:235], v[222:223], v[226:227] op_sel:[1,1,0] op_sel_hi:[0,1,1] neg_lo:[1,0,0]
    v_cvt_pk_bf16_f32 v216, v224, v225
    ds_write_b32 v1, v216 offset:20064
    v_pk_mul_f32 v[228:229], v[236:237], v[222:223] op_sel:[0,0] op_sel_hi:[1,0]
    v_pk_fma_f32 v[228:229], v[236:237], v[222:223], v[228:229] op_sel:[1,1,0] op_sel_hi:[0,1,1] neg_lo:[1,0,0]
    v_cvt_pk_bf16_f32 v217, v226, v227
    ds_write_b32 v1, v217 offset:20592
    v_pk_mul_f32 v[230:231], v[238:239], v[222:223] op_sel:[0,0] op_sel_hi:[1,0]
    v_pk_fma_f32 v[230:231], v[238:239], v[222:223], v[230:231] op_sel:[1,1,0] op_sel_hi:[0,1,1] neg_lo:[1,0,0]
    v_cvt_pk_bf16_f32 v218, v228, v229
    ds_write_b32 v1, v218 offset:21120
    v_pk_mul_f32 v[232:233], v[224:225], v[222:223] op_sel:[0,0] op_sel_hi:[1,0]
    v_pk_fma_f32 v[232:233], v[224:225], v[222:223], v[232:233] op_sel:[1,1,0] op_sel_hi:[0,1,1] neg_lo:[1,0,0]
    v_cvt_pk_bf16_f32 v219, v230, v231
    ds_write_b32 v1, v219 offset:21648
    v_pk_mul_f32 v[234:235], v[226:227], v[222:223] op_sel:[0,0] op_sel_hi:[1,0]
    v_pk_fma_f32 v[234:235], v[226:227], v[222:223], v[234:235] op_sel:[1,1,0] op_sel_hi:[0,1,1] neg_lo:[1,0,0]
    v_cvt_pk_bf16_f32 v216, v232, v233
    ds_write_b32 v1, v216 offset:22176
    v_pk_mul_f32 v[236:237], v[228:229], v[222:223] op_sel:[0,0] op_sel_hi:[1,0]
    v_pk_fma_f32 v[236:237], v[228:229], v[222:223], v[236:237] op_sel:[1,1,0] op_sel_hi:[0,1,1] neg_lo:[1,0,0]
    v_cvt_pk_bf16_f32 v217, v234, v235
    ds_write_b32 v1, v217 offset:22704
    v_pk_mul_f32 v[238:239], v[230:231], v[222:223] op_sel:[0,0] op_sel_hi:[1,0]
    v_pk_fma_f32 v[238:239], v[230:231], v[222:223], v[238:239] op_sel:[1,1,0] op_sel_hi:[0,1,1] neg_lo:[1,0,0]
    v_cvt_pk_bf16_f32 v218, v236, v237
    ds_write_b32 v1, v218 offset:23232
    v_pk_mul_f32 v[224:225], v[232:233], v[222:223] op_sel:[0,0] op_sel_hi:[1,0]
    v_pk_fma_f32 v[224:225], v[232:233], v[222:223], v[224:225] op_sel:[1,1,0] op_sel_hi:[0,1,1] neg_lo:[1,0,0]
    v_cvt_pk_bf16_f32 v219, v238, v239
    ds_write_b32 v1, v219 offset:23760
    v_pk_mul_f32 v[226:227], v[234:235], v[222:223] op_sel:[0,0] op_sel_hi:[1,0]
    v_pk_fma_f32 v[226:227], v[234:235], v[222:223], v[226:227] op_sel:[1,1,0] op_sel_hi:[0,1,1] neg_lo:[1,0,0]
    v_cvt_pk_bf16_f32 v216, v224, v225
    ds_write_b32 v1, v216 offset:24288
    v_pk_mul_f32 v[228:229], v[236:237], v[222:223] op_sel:[0,0] op_sel_hi:[1,0]
    v_pk_fma_f32 v[228:229], v[236:237], v[222:223], v[228:229] op_sel:[1,1,0] op_sel_hi:[0,1,1] neg_lo:[1,0,0]
    v_cvt_pk_bf16_f32 v217, v226, v227
    ds_write_b32 v1, v217 offset:24816
    v_pk_mul_f32 v[230:231], v[238:239], v[222:223] op_sel:[0,0] op_sel_hi:[1,0]
    v_pk_fma_f32 v[230:231], v[238:239], v[222:223], v[230:231] op_sel:[1,1,0] op_sel_hi:[0,1,1] neg_lo:[1,0,0]
    v_cvt_pk_bf16_f32 v218, v228, v229
    ds_write_b32 v1, v218 offset:25344
    v_pk_mul_f32 v[232:233], v[224:225], v[222:223] op_sel:[0,0] op_sel_hi:[1,0]
    v_pk_fma_f32 v[232:233], v[224:225], v[222:223], v[232:233] op_sel:[1,1,0] op_sel_hi:[0,1,1] neg_lo:[1,0,0]
    v_cvt_pk_bf16_f32 v219, v230, v231
    ds_write_b32 v1, v219 offset:25872
    v_pk_mul_f32 v[234:235], v[226:227], v[222:223] op_sel:[0,0] op_sel_hi:[1,0]
    v_pk_fma_f32 v[234:235], v[226:227], v[222:223], v[234:235] op_sel:[1,1,0] op_sel_hi:[0,1,1] neg_lo:[1,0,0]
    v_cvt_pk_bf16_f32 v216, v232, v233
    ds_write_b32 v1, v216 offset:26400
    v_pk_mul_f32 v[236:237], v[228:229], v[222:223] op_sel:[0,0] op_sel_hi:[1,0]
    v_pk_fma_f32 v[236:237], v[228:229], v[222:223], v[236:237] op_sel:[1,1,0] op_sel_hi:[0,1,1] neg_lo:[1,0,0]
    v_cvt_pk_bf16_f32 v217, v234, v235
    ds_write_b32 v1, v217 offset:26928
    v_pk_mul_f32 v[238:239], v[230:231], v[222:223] op_sel:[0,0] op_sel_hi:[1,0]
    v_pk_fma_f32 v[238:239], v[230:231], v[222:223], v[238:239] op_sel:[1,1,0] op_sel_hi:[0,1,1] neg_lo:[1,0,0]
    v_cvt_pk_bf16_f32 v218, v236, v237
    ds_write_b32 v1, v218 offset:27456
    v_cvt_pk_bf16_f32 v219, v238, v239
    ds_write_b32 v1, v219 offset:27984
    s_add_u32 m0, s55, 49152
    s_add_u32 s34, s44, 1
    s_and_b32 s34, s34, 7
    s_mul_i32 s34, s34, 229376
    s_add_u32 s34, s34, s64
    buffer_load_dwordx4 v12, s[8:11], s34 offen lds
    s_add_u32 m0, s55, 57344
    s_nop 0
    buffer_load_dwordx4 v13, s[12:15], s34 offen lds
    s_add_u32 m0, s55, 53248
    s_add_u32 s34, s44, 1
    s_and_b32 s34, s34, 7
    s_mul_i32 s34, s34, 229376
    s_add_u32 s34, s34, s64
    s_add_u32 s34, s34, 114688
    buffer_load_dwordx4 v12, s[8:11], s34 offen lds
    s_add_u32 m0, s55, 61440
    s_nop 0
    buffer_load_dwordx4 v13, s[12:15], s34 offen lds
    s_add_u32 m0, s54, 0
    s_add_u32 s34, s44, 1
    s_and_b32 s34, s34, 7
    s_mul_i32 s34, s34, 128
    s_add_u32 s34, s34, s53
    buffer_load_dwordx4 v4, s[4:7], s34 offen lds
    buffer_load_dwordx4 v5, s[4:7], s34 offen offset:1024 lds
    s_add_u32 m0, s54, 8192
    s_add_u32 s34, s44, 1
    s_and_b32 s34, s34, 7
    s_mul_i32 s34, s34, 128
    s_add_u32 s34, s34, s53
    s_add_u32 s34, s34, 65536
    buffer_load_dwordx4 v4, s[4:7], s34 offen lds
    buffer_load_dwordx4 v5, s[4:7], s34 offen offset:1024 lds
    s_branch Gkj
Gk1:
    v_mul_f32 v210, v214, v210
    v_mul_f32 v211, v214, v211
    v_xor_b32 v209, 0x80000000, v209
    v_mul_f32 v220, 0x3fb8aa3b, v208
    v_mul_f32 v221, 0x3e22f983, v209
    v_exp_f32 v220, v220
    v_fract_f32 v221, v221
    v_cos_f32 v222, v221
    v_sin_f32 v223, v221
    v_mul_f32 v222, v222, v220
    v_mul_f32 v223, v223, v220
    v_pk_mul_f32 v[230:231], v[212:213], v[210:211] op_sel:[0,0] op_sel_hi:[1,0]
    v_pk_fma_f32 v[230:231], v[212:213], v[210:211], v[230:231] op_sel:[1,1,0] op_sel_hi:[0,1,1] neg_lo:[1,0,0]
    v_mul_f32 v220, 0x43b8aa3b, v208
    v_mul_f32 v221, 0x4222f983, v209
    v_exp_f32 v220, v220
    v_fract_f32 v221, v221
    v_cos_f32 v228, v221
    v_sin_f32 v229, v221
    v_mul_f32 v228, v228, v220
    v_mul_f32 v229, v229, v220
    v_xor_b32 v231, 0x80000000, v231
    v_pk_mul_f32 v[224:225], v[222:223], v[222:223] op_sel:[0,0] op_sel_hi:[1,0]
    v_pk_fma_f32 v[224:225], v[222:223], v[222:223], v[224:225] op_sel:[1,1,0] op_sel_hi:[0,1,1] neg_lo:[1,0,0]
    v_pk_mul_f32 v[232:233], v[230:231], v[222:223] op_sel:[0,0] op_sel_hi:[1,0]
    v_pk_fma_f32 v[232:233], v[230:231], v[222:223], v[232:233] op_sel:[1,1,0] op_sel_hi:[0,1,1] neg_lo:[1,0,0]
    v_cvt_pk_bf16_f32 v216, v230, v231
    s_cmp_lg_u32 s101, 3
    s_cbranch_scc1 Lo_17
    v_min_u32 v70, 19, v0
    v_lshlrev_b32 v70, 7, v70
    s_sub_u32 s3, s2, 32
    s_mul_i32 s3, s3, 2560
    s_add_u32 s3, s3, 0
    buffer_load_dword v70, v70, s[56:59], s3 offen
Lo_17:
    ds_write_b32 v1, v216 offset:0
    v_pk_mul_f32 v[226:227], v[224:225], v[224:225] op_sel:[0,0] op_sel_hi:[1,0]
    v_pk_fma_f32 v[226:227], v[224:225], v[224:225], v[226:227] op_sel:[1,1,0] op_sel_hi:[0,1,1] neg_lo:[1,0,0]
    v_pk_mul_f32 v[234:235], v[230:231], v[224:225] op_sel:[0,0] op_sel_hi:[1,0]
    v_pk_fma_f32 v[234:235], v[230:231], v[224:225], v[234:235] op_sel:[1,1,0] op_sel_hi:[0,1,1] neg_lo:[1,0,0]
    v_cvt_pk_bf16_f32 v217, v232, v233
    ds_write_b32 v1, v217 offset:528
    v_pk_mul_f32 v[236:237], v[232:233], v[224:225] op_sel:[0,0] op_sel_hi:[1,0]
    v_pk_fma_f32 v[236:237], v[232:233], v[224:225], v[236:237] op_sel:[1,1,0] op_sel_hi:[0,1,1] neg_lo:[1,0,0]
    v_cvt_pk_bf16_f32 v218, v234, v235
    ds_write_b32 v1, v218 offset:1056
    v_pk_mul_f32 v[238:239], v[230:231], v[226:227] op_sel:[0,0] op_sel_hi:[1,0]
    v_pk_fma_f32 v[238:239], v[230:231], v[226:227], v[238:239] op_sel:[1,1,0] op_sel_hi:[0,1,1] neg_lo:[1,0,0]
    v_cvt_pk_bf16_f32 v219, v236, v237
    ds_write_b32 v1, v219 offset:1584
    v_pk_mul_f32 v[240:241], v[232:233], v[226:227] op_sel:[0,0] op_sel_hi:[1,0]
    v_pk_fma_f32 v[240:241], v[232:233], v[226:227], v[240:241] op_sel:[1,1,0] op_sel_hi:[0,1,1] neg_lo:[1,0,0]
    v_cvt_pk_bf16_f32 v216, v238, v239
    ds_write_b32 v1, v216 offset:2112
    v_pk_mul_f32 v[242:243], v[234:235], v[226:227] op_sel:[0,0] op_sel_hi:[1,0]
    v_pk_fma_f32 v[242:243], v[234:235], v[226:227], v[242:243] op_sel:[1,1,0] op_sel_hi:[0,1,1] neg_lo:[1,0,0]
    v_cvt_pk_bf16_f32 v217, v240, v241
    ds_write_b32 v1, v217 offset:2640
    v_pk_mul_f32 v[244:245], v[236:237], v[226:227] op_sel:[0,0] op_sel_hi:[1,0]
    v_pk_fma_f32 v[244:245], v[236:237], v[226:227], v[244:245] op_sel:[1,1,0] op_sel_hi:[0,1,1] neg_lo:[1,0,0]
    v_cvt_pk_bf16_f32 v218, v242, v243
    ds_write_b32 v1, v218 offset:3168
    v_pk_mul_f32 v[246:247], v[230:231], v[228:229] op_sel:[0,0] op_sel_hi:[1,0]
    v_pk_fma_f32 v[246:247], v[230:231], v[228:229], v[246:247] op_sel:[1,1,0] op_sel_hi:[0,1,1] neg_lo:[1,0,0]
    v_cvt_pk_bf16_f32 v219, v244, v245
    ds_write_b32 v1, v219 offset:3696
    v_pk_mul_f32 v[248:249], v[234:235], v[228:229] op_sel:[0,0] op_sel_hi:[1,0]
    v_pk_fma_f32 v[248:249], v[234:235], v[228:229], v[248:249] op_sel:[1,1,0] op_sel_hi:[0,1,1] neg_lo:[1,0,0]
    v_cvt_pk_bf16_f32 v216, v246, v247
    ds_write_b32 v1, v216 offset:4224
    v_pk_mul_f32 v[250:251], v[238:239], v[228:229] op_sel:[0,0] op_sel_hi:[1,0]
    v_pk_fma_f32 v[250:251], v[238:239], v[228:229], v[250:251] op_sel:[1,1,0] op_sel_hi:[0,1,1] neg_lo:[1,0,0]
    v_cvt_pk_bf16_f32 v217, v248, v249
    ds_write_b32 v1, v217 offset:4752
    v_pk_mul_f32 v[252:253], v[242:243], v[228:229] op_sel:[0,0] op_sel_hi:[1,0]
    v_pk_fma_f32 v[252:253], v[242:243], v[228:229], v[252:253] op_sel:[1,1,0] op_sel_hi:[0,1,1] neg_lo:[1,0,0]
    v_cvt_pk_bf16_f32 v218, v250, v251
    ds_write_b32 v1, v218 offset:5280
    v_pk_mul_f32 v[254:255], v[246:247], v[228:229] op_sel:[0,0] op_sel_hi:[1,0]
    v_pk_fma_f32 v[254:255], v[246:247], v[228:229], v[254:255] op_sel:[1,1,0] op_sel_hi:[0,1,1] neg_lo:[1,0,0]
    v_cvt_pk_bf16_f32 v219, v252, v253
    ds_write_b32 v1, v219 offset:5808
    v_pk_mul_f32 v[222:223], v[250:251], v[228:229] op_sel:[0,0] op_sel_hi:[1,0]
    v_pk_fma_f32 v[222:223], v[250:251], v[228:229], v[222:223] op_sel:[1,1,0] op_sel_hi:[0,1,1] neg_lo:[1,0,0]
    v_cvt_pk_bf16_f32 v216, v254, v255
    ds_write_b32 v1, v216 offset:6336
    v_pk_mul_f32 v[230:231], v[254:255], v[228:229] op_sel:[0,0] op_sel_hi:[1,0]
    v_pk_fma_f32 v[230:231], v[254:255], v[228:229], v[230:231] op_sel:[1,1,0] op_sel_hi:[0,1,1] neg_lo:[1,0,0]
    v_cvt_pk_bf16_f32 v217, v222, v223
    ds_write_b32 v1, v217 offset:10560
    v_pk_mul_f32 v[224:225], v[222:223], v[228:229] op_sel:[0,0] op_sel_hi:[1,0]
    v_pk_fma_f32 v[224:225], v[222:223], v[228:229], v[224:225] op_sel:[1,1,0] op_sel_hi:[0,1,1] neg_lo:[1,0,0]
    v_cvt_pk_bf16_f32 v218, v230, v231
    ds_write_b32 v1, v218 offset:6864
    v_pk_mul_f32 v[232:233], v[230:231], v[228:229] op_sel:[0,0] op_sel_hi:[1,0]
    v_pk_fma_f32 v[232:233], v[230:231], v[228:229], v[232:233] op_sel:[1,1,0] op_sel_hi:[0,1,1] neg_lo:[1,0,0]
    v_cvt_pk_bf16_f32 v219, v224, v225
    ds_write_b32 v1, v219 offset:11088
    v_pk_mul_f32 v[234:235], v[232:233], v[228:229] op_sel:[0,0] op_sel_hi:[1,0]
    v_pk_fma_f32 v[234:235], v[232:233], v[228:229], v[234:235] op_sel:[1,1,0] op_sel_hi:[0,1,1] neg_lo:[1,0,0]
    v_cvt_pk_bf16_f32 v216, v232, v233
    ds_write_b32 v1, v216 offset:7392
    v_pk_mul_f32 v[236:237], v[234:235], v[228:229] op_sel:[0,0] op_sel_hi:[1,0]
    v_pk_fma_f32 v[236:237], v[234:235], v[228:229], v[236:237] op_sel:[1,1,0] op_sel_hi:[0,1,1] neg_lo:[1,0,0]
    v_cvt_pk_bf16_f32 v217, v234, v235
    ds_write_b32 v1, v217 offset:7920
    v_pk_mul_f32 v[238:239], v[236:237], v[228:229] op_sel:[0,0] op_sel_hi:[1,0]
    v_pk_fma_f32 v[238:239], v[236:237], v[228:229], v[238:239] op_sel:[1,1,0] op_sel_hi:[0,1,1] neg_lo:[1,0,0]
    v_cvt_pk_bf16_f32 v218, v236, v237
    ds_write_b32 v1, v218 offset:8448
    v_pk_mul_f32 v[240:241], v[238:239], v[228:229] op_sel:[0,0] op_sel_hi:[1,0]
    v_pk_fma_f32 v[240:241], v[238:239], v[228:229], v[240:241] op_sel:[1,1,0] op_sel_hi:[0,1,1] neg_lo:[1,0,0]
    v_cvt_pk_bf16_f32 v219, v238, v239
    ds_write_b32 v1, v219 offset:8976
    v_cvt_pk_bf16_f32 v216, v240, v241
    ds_write_b32 v1, v216 offset:9504
Gkj:
    s_waitcnt lgkmcnt(0)
    s_barrier
    ds_read_b128 v[224:227], v32 offset:0
    ds_read_b128 v[228:231], v33 offset:0
    s_add_u32 s100, s100, 1
    s_lshl_b32 s3, s68, 4
    s_lshr_b32 s93, s93, s3
    s_lshl_b32 s93, s93, 16
    s_cmp_lt_u32 s101, 2
    s_cselect_b32 s93, s93, 0
    v_mov_b32 v39, 0
    v_writelane_b32 v39, s93, 0
    ds_read_b128 v[232:235], v32 offset:16
    ds_read_b128 v[236:239], v33 offset:16
    s_mul_i32 s99, s67, 3072
    v_add_u32_sdwa v44, s99, v40 dst_sel:DWORD dst_unused:UNUSED_PAD src0_sel:DWORD src1_sel:WORD_0
    ds_read_b128 v[240:243], v32 offset:32
    ds_read_b128 v[244:247], v33 offset:32
    v_add_u32_sdwa v45, s99, v40 dst_sel:DWORD dst_unused:UNUSED_PAD src0_sel:DWORD src1_sel:WORD_1
    v_add_u32_sdwa v46, s99, v41 dst_sel:DWORD dst_unused:UNUSED_PAD src0_sel:DWORD src1_sel:WORD_0
    ds_read_b128 v[248:251], v32 offset:48
    ds_read_b128 v[252:255], v33 offset:48
    v_add_u32_sdwa v47, s99, v41 dst_sel:DWORD dst_unused:UNUSED_PAD src0_sel:DWORD src1_sel:WORD_1
    v_add_u32_sdwa v48, s99, v42 dst_sel:DWORD dst_unused:UNUSED_PAD src0_sel:DWORD src1_sel:WORD_0
    ds_read_b128 v[192:195], v32 offset:64
    ds_read_b128 v[196:199], v33 offset:64
    v_add_u32_sdwa v49, s99, v42 dst_sel:DWORD dst_unused:UNUSED_PAD src0_sel:DWORD src1_sel:WORD_1
    v_add_u32_sdwa v50, s99, v43 dst_sel:DWORD dst_unused:UNUSED_PAD src0_sel:DWORD src1_sel:WORD_0
    ds_read_b128 v[200:203], v32 offset:80
    ds_read_b128 v[204:207], v33 offset:80
    s_mul_i32 s3, s67, 15552
    s_add_u32 s3, s3, 115200
    v_add_u32_sdwa v51, s3, v43 dst_sel:DWORD dst_unused:UNUSED_PAD src0_sel:DWORD src1_sel:WORD_1
    ds_read_b128 v[208:211], v32 offset:96
    ds_read_b128 v[212:215], v33 offset:96
    s_mul_i32 s3, s67, 8448
    s_lshl_b32 s98, s90, 9
    s_add_u32 s3, s3, s98
    s_add_u32 s3, s3, 98304
    v_lshl_add_u32 v52, v0, 3, s3
    ds_read_b128 v[216:219], v32 offset:112
    ds_read_b128 v[220:223], v33 offset:112
    v_mov_b32 v54, 0
    v_mov_b32 v55, 0
    s_waitcnt lgkmcnt(14)
    v_mfma_f32_16x16x32_bf16 v[60:63], v[224:227], v[228:231], 0
    s_waitcnt lgkmcnt(12)
    v_mfma_f32_16x16x32_bf16 v[60:63], v[232:235], v[236:239], v[60:63]
    s_waitcnt lgkmcnt(10)
    v_mfma_f32_16x16x32_bf16 v[60:63], v[240:243], v[244:247], v[60:63]
    s_waitcnt lgkmcnt(8)
    v_mfma_f32_16x16x32_bf16 v[60:63], v[248:251], v[252:255], v[60:63]
    s_waitcnt lgkmcnt(6)
    v_mfma_f32_16x16x32_bf16 v[60:63], v[192:195], v[196:199], v[60:63]
    s_waitcnt lgkmcnt(4)
    v_mfma_f32_16x16x32_bf16 v[60:63], v[200:203], v[204:207], v[60:63]
    s_waitcnt lgkmcnt(2)
    v_mfma_f32_16x16x32_bf16 v[60:63], v[208:211], v[212:215], v[60:63]
    s_waitcnt lgkmcnt(0)
    v_mfma_f32_16x16x32_bf16 v[60:63], v[216:219], v[220:223], v[60:63]
    s_mul_i32 s3, s68, 3072
    s_lshr_b32 s98, s101, 1
    s_mul_i32 s98, s98, 768
    s_add_u32 m0, s3, s98
    s_nop 0
    ds_write_addtid_b32 v31 offset:16896
    buffer_load_dwordx4 v[80:83], v6, s[60:63], s45 offen
    s_add_u32 s3, s45, 28672
    buffer_load_dwordx4 v[84:87], v6, s[60:63], s3 offen
    v_add_f32 v60, v60, v39
    v_cvt_pk_bf16_f32 v62, v62, v63
    v_cvt_pk_bf16_f32 v60, v60, v61
    ds_write_addtid_b32 v62 offset:16640
    ds_write_addtid_b32 v60 offset:16384
    s_waitcnt lgkmcnt(0)
    s_barrier
    ds_read_u16 v44, v44 offset:16384
    ds_read_u16 v45, v45 offset:16384
    ds_read_u16 v46, v46 offset:16384
    ds_read_u16 v47, v47 offset:16384
    ds_read_u16 v48, v48 offset:16384
    ds_read_u16 v49, v49 offset:16384
    ds_read_u16 v50, v50 offset:16384
    ds_write_b64 v51, v[54:55]
    s_waitcnt lgkmcnt(6)
    v_lshl_or_b32 v38, v45, 16, v44
    s_waitcnt lgkmcnt(4)
    v_lshl_or_b32 v39, v47, 16, v46
    ds_write_b64 v52, v[38:39] offset:6336
    v_lshl_or_b32 v36, v46, 16, v45
    s_waitcnt lgkmcnt(4)
    v_lshl_or_b32 v37, v48, 16, v47
    ds_write_b64 v52, v[36:37] offset:4224
    v_lshl_or_b32 v34, v47, 16, v46
    s_waitcnt lgkmcnt(4)
    v_lshl_or_b32 v35, v49, 16, v48
    ds_write_b64 v52, v[34:35] offset:2112
    v_lshl_or_b32 v32, v48, 16, v47
    s_waitcnt lgkmcnt(4)
    v_lshl_or_b32 v33, v50, 16, v49
    ds_write_b64 v52, v[32:33] offset:0
    s_waitcnt vmcnt(10)
    s_cmp_lt_u32 s101, 4
    s_cbranch_scc1 Lw0s
    s_waitcnt vmcnt(2)
Lw0s:
    s_waitcnt lgkmcnt(0)
    s_barrier
    ds_read_b128 v[128:131], v8 offset:32768
    ds_read_b64_tr_b16 v[96:97], v14 offset:32768
    ds_read_b64_tr_b16 v[98:99], v14 offset:33280
    ds_read_b64_tr_b16 v[100:101], v15 offset:32768
    ds_read_b64_tr_b16 v[102:103], v15 offset:33280
    ds_read_b128 v[132:135], v9 offset:32768
    ds_read_b64_tr_b16 v[104:105], v14 offset:34816
    ds_read_b64_tr_b16 v[106:107], v14 offset:35328
    ds_read_b64_tr_b16 v[108:109], v15 offset:34816
    ds_read_b64_tr_b16 v[110:111], v15 offset:35328
    ds_read_b128 v[136:139], v10 offset:32768
    ds_read_b64_tr_b16 v[112:113], v14 offset:36864
    ds_read_b64_tr_b16 v[114:115], v14 offset:37376
    ds_read_b64_tr_b16 v[116:117], v15 offset:36864
    ds_read_b64_tr_b16 v[118:119], v15 offset:37376
    ds_read_b128 v[140:143], v11 offset:32768
    ds_read_b64_tr_b16 v[120:121], v14 offset:38912
    ds_read_b64_tr_b16 v[122:123], v14 offset:39424
    ds_read_b64_tr_b16 v[124:125], v15 offset:38912
    ds_read_b64_tr_b16 v[126:127], v15 offset:39424
    ds_read_b64_tr_b16 v[64:65], v68
    ds_read_b64_tr_b16 v[66:67], v68 offset:512
    s_waitcnt lgkmcnt(15)
    v_mfma_f32_32x32x16_bf16 v[32:47], v[96:99], v[128:131], 0
    s_add_u32 m0, s54, 16384
    s_add_u32 s34, s44, 2
    s_and_b32 s34, s34, 7
    s_mul_i32 s34, s34, 128
    s_add_u32 s34, s34, s53
    buffer_load_dwordx4 v4, s[4:7], s34 offen lds
    v_mfma_f32_32x32x16_bf16 v[48:63], v[100:103], v[128:131], 0
    buffer_load_dwordx4 v5, s[4:7], s34 offen offset:1024 lds
    s_add_u32 m0, s55, 65536
    s_add_u32 s34, s44, 2
    s_and_b32 s34, s34, 7
    s_mul_i32 s34, s34, 229376
    s_add_u32 s34, s34, s64
    buffer_load_dwordx4 v12, s[8:11], s34 offen lds
    s_waitcnt lgkmcnt(14)
    v_mfma_f32_32x32x16_bf16 v[32:47], v[104:107], v[132:135], v[32:47]
    s_waitcnt lgkmcnt(12)
    v_mfma_f32_32x32x16_bf16 v[48:63], v[108:111], v[132:135], v[48:63]
    s_add_u32 m0, s55, 73728
    s_nop 0
    buffer_load_dwordx4 v13, s[12:15], s34 offen lds
    s_waitcnt lgkmcnt(0)
    buffer_store_dwordx4 v[64:67], v2, s[56:59], s41 offen sc1
    s_waitcnt vmcnt(7)
    s_barrier
    v_mfma_f32_32x32x16_bf16 v[32:47], v[112:115], v[136:139], v[32:47]
    ds_read_b128 v[144:147], v8 offset:0
    ds_read_b64_tr_b16 v[96:97], v14 offset:0
    ds_read_b64_tr_b16 v[98:99], v14 offset:512
    ds_read_b64_tr_b16 v[100:101], v15 offset:0
    ds_read_b64_tr_b16 v[102:103], v15 offset:512
    s_add_u32 m0, s54, 32768
    s_add_u32 s34, s44, 3
    s_and_b32 s34, s34, 7
    s_mul_i32 s34, s34, 128
    s_add_u32 s34, s34, s53
    buffer_load_dwordx4 v4, s[4:7], s34 offen lds
    s_waitcnt vmcnt(7)
    v_mfma_f32_16x16x32_bf16 v[92:95], v[88:91], v[80:83], 0
    v_mfma_f32_32x32x16_bf16 v[48:63], v[116:119], v[136:139], v[48:63]
    ds_read_b128 v[148:151], v9 offset:0
    ds_read_b64_tr_b16 v[104:105], v14 offset:2048
    ds_read_b64_tr_b16 v[106:107], v14 offset:2560
    ds_read_b64_tr_b16 v[108:109], v15 offset:2048
    ds_read_b64_tr_b16 v[110:111], v15 offset:2560
    s_waitcnt vmcnt(6)
    v_mfma_f32_16x16x32_bf16 v[92:95], v[88:91], v[84:87], v[92:95]
    v_mfma_f32_32x32x16_bf16 v[32:47], v[120:123], v[140:143], v[32:47]
    ds_read_b128 v[152:155], v10 offset:0
    ds_read_b64_tr_b16 v[112:113], v14 offset:4096
    ds_read_b64_tr_b16 v[114:115], v14 offset:4608
    buffer_load_dwordx4 v5, s[4:7], s34 offen offset:1024 lds
    v_mfma_f32_32x32x16_bf16 v[48:63], v[124:127], v[140:143], v[48:63]
    ds_read_b64_tr_b16 v[116:117], v15 offset:4096
    ds_read_b64_tr_b16 v[118:119], v15 offset:4608
    s_add_u32 m0, s55, 81920
    s_add_u32 s34, s44, 3
    s_and_b32 s34, s34, 7
    s_mul_i32 s34, s34, 229376
    s_add_u32 s34, s34, s64
    buffer_load_dwordx4 v12, s[8:11], s34 offen lds
    ds_write_b128 v20, v[92:95]
    s_waitcnt lgkmcnt(13)
    v_mfma_f32_32x32x16_bf16 v[32:47], v[96:99], v[144:147], v[32:47]
    ds_read_b128 v[156:159], v11 offset:0
    ds_read_b64_tr_b16 v[120:121], v14 offset:6144
    ds_read_b64_tr_b16 v[122:123], v14 offset:6656
    s_waitcnt lgkmcnt(14)
    v_mfma_f32_32x32x16_bf16 v[48:63], v[100:103], v[144:147], v[48:63]
    ds_read_b64_tr_b16 v[124:125], v15 offset:6144
    ds_read_b64_tr_b16 v[126:127], v15 offset:6656
    s_add_u32 m0, s55, 90112
    s_nop 0
    buffer_load_dwordx4 v13, s[12:15], s34 offen lds
    s_waitcnt lgkmcnt(13)
    v_mfma_f32_32x32x16_bf16 v[32:47], v[104:107], v[148:151], v[32:47]
    s_waitcnt lgkmcnt(11)
    v_mfma_f32_32x32x16_bf16 v[48:63], v[108:111], v[148:151], v[48:63]
    s_waitcnt vmcnt(5)
    s_waitcnt lgkmcnt(0)
    s_barrier
    v_mfma_f32_32x32x16_bf16 v[32:47], v[112:115], v[152:155], v[32:47]
    s_cmp_lg_u32 s101, 0
    s_cbranch_scc1 Lo_18
    v_lshlrev_b32 v20, 2, v0
    v_add_u32 v20, 146304, v20
    ds_read2st64_b32 v[80:81], v20 offset0:0 offset1:1
    ds_read2st64_b32 v[82:83], v20 offset0:2 offset1:3
    ds_read2st64_b32 v[84:85], v20 offset0:4 offset1:5
    ds_read2st64_b32 v[86:87], v20 offset0:6 offset1:7
    ds_read2st64_b32 v[88:89], v20 offset0:8 offset1:9
    ds_read2st64_b32 v[90:91], v20 offset0:10 offset1:11
    ds_read2st64_b32 v[92:93], v20 offset0:12 offset1:13
    ds_read2st64_b32 v[94:95], v20 offset0:14 offset1:15
    v_and_b32 v20, 3, v0
    v_and_b32 v3, 8, v0
    v_lshl_or_b32 v20, v20, 1, v3
    v_and_b32 v3, 4, v0
    v_lshl_or_b32 v20, v3, 2, v20
    v_and_b32 v3, 16, v0
    v_lshl_or_b32 v20, v3, 3, v20
    v_and_b32 v3, 32, v0
    v_lshl_or_b32 v20, v3, 4, v20
    v_lshlrev_b32 v20, 3, v20
Lo_18:
    ds_read_b128 v[160:163], v8 offset:16384
    ds_read_b64_tr_b16 v[96:97], v14 offset:16384
    ds_read_b64_tr_b16 v[98:99], v14 offset:16896
    ds_read_b64_tr_b16 v[100:101], v15 offset:16384
    ds_read_b64_tr_b16 v[102:103], v15 offset:16896
    s_add_u32 m0, s54, 0
    s_add_u32 s34, s44, 4
    s_and_b32 s34, s34, 7
    s_mul_i32 s34, s34, 128
    s_add_u32 s34, s34, s53
    buffer_load_dwordx4 v4, s[4:7], s34 offen lds
    v_mfma_f32_32x32x16_bf16 v[48:63], v[116:119], v[152:155], v[48:63]
    ds_read_b128 v[164:167], v9 offset:16384
    ds_read_b64_tr_b16 v[104:105], v14 offset:18432
    ds_read_b64_tr_b16 v[106:107], v14 offset:18944
    ds_read_b64_tr_b16 v[108:109], v15 offset:18432
    ds_read_b64_tr_b16 v[110:111], v15 offset:18944
    v_mfma_f32_32x32x16_bf16 v[32:47], v[120:123], v[156:159], v[32:47]
    ds_read_b128 v[168:171], v10 offset:16384
    ds_read_b64_tr_b16 v[112:113], v14 offset:20480
    ds_read_b64_tr_b16 v[114:115], v14 offset:20992
    buffer_load_dwordx4 v5, s[4:7], s34 offen offset:1024 lds
    v_mfma_f32_32x32x16_bf16 v[48:63], v[124:127], v[156:159], v[48:63]
    ds_read_b64_tr_b16 v[116:117], v15 offset:20480
    ds_read_b64_tr_b16 v[118:119], v15 offset:20992
    s_add_u32 m0, s55, 49152
    s_add_u32 s34, s44, 4
    s_and_b32 s34, s34, 7
    s_mul_i32 s34, s34, 229376
    s_add_u32 s34, s34, s64
    buffer_load_dwordx4 v12, s[8:11], s34 offen lds
    s_cmp_lg_u32 s101, 0
    s_cbranch_scc1 Lo_19
    s_waitcnt lgkmcnt(15)
    v_add_f32 v80, v80, v81
    v_add_f32 v82, v82, v83
    v_add_f32 v84, v84, v85
    v_add_f32 v86, v86, v87
    v_add_f32 v88, v88, v89
    v_add_f32 v90, v90, v91
    v_add_f32 v92, v92, v93
    v_add_f32 v94, v94, v95
    v_add_f32 v80, v80, v82
    v_add_f32 v84, v84, v86
    v_add_f32 v88, v88, v90
    v_add_f32 v92, v92, v94
    v_add_f32 v80, v80, v84
    v_add_f32 v88, v88, v92
    v_add_f32 v80, v80, v88
    v_cvt_pk_bf16_f32 v81, v80, v80
    v_and_b32 v81, 0xffff0000, v81
    v_sub_f32 v81, v80, v81
    v_cvt_pk_bf16_f32 v80, v80, v81
    v_mov_b32 v81, s100
    buffer_store_dwordx2 v[80:81], v20, s[56:59], s66 offen sc1
Lo_19:
    s_waitcnt lgkmcnt(12)
    v_mfma_f32_32x32x16_bf16 v[32:47], v[96:99], v[160:163], v[32:47]
    ds_read_b128 v[172:175], v11 offset:16384
    ds_read_b64_tr_b16 v[120:121], v14 offset:22528
    ds_read_b64_tr_b16 v[122:123], v14 offset:23040
    s_waitcnt lgkmcnt(13)
    v_mfma_f32_32x32x16_bf16 v[48:63], v[100:103], v[160:163], v[48:63]
    ds_read_b64_tr_b16 v[124:125], v15 offset:22528
    ds_read_b64_tr_b16 v[126:127], v15 offset:23040
    s_add_u32 m0, s55, 57344
    s_nop 0
    buffer_load_dwordx4 v13, s[12:15], s34 offen lds
    s_waitcnt lgkmcnt(12)
    v_mfma_f32_32x32x16_bf16 v[32:47], v[104:107], v[164:167], v[32:47]
    s_waitcnt lgkmcnt(10)
    v_mfma_f32_32x32x16_bf16 v[48:63], v[108:111], v[164:167], v[48:63]
    s_waitcnt vmcnt(8)
    s_waitcnt vmcnt(4)
    s_waitcnt lgkmcnt(0)
    s_barrier
    v_mfma_f32_32x32x16_bf16 v[32:47], v[112:115], v[168:171], v[32:47]
    ds_read_b128 v[176:179], v8 offset:32768
    ds_read_b64_tr_b16 v[96:97], v14 offset:32768
    ds_read_b64_tr_b16 v[98:99], v14 offset:33280
    ds_read_b64_tr_b16 v[100:101], v15 offset:32768
    ds_read_b64_tr_b16 v[102:103], v15 offset:33280
    s_add_u32 m0, s54, 16384
    s_add_u32 s34, s44, 5
    s_and_b32 s34, s34, 7
    s_mul_i32 s34, s34, 128
    s_add_u32 s34, s34, s53
    buffer_load_dwordx4 v4, s[4:7], s34 offen lds
    v_mfma_f32_32x32x16_bf16 v[48:63], v[116:119], v[168:171], v[48:63]
    ds_read_b128 v[180:183], v9 offset:32768
    ds_read_b64_tr_b16 v[104:105], v14 offset:34816
    ds_read_b64_tr_b16 v[106:107], v14 offset:35328
    ds_read_b64_tr_b16 v[108:109], v15 offset:34816
    ds_read_b64_tr_b16 v[110:111], v15 offset:35328
    v_mfma_f32_32x32x16_bf16 v[32:47], v[120:123], v[172:175], v[32:47]
    ds_read_b128 v[184:187], v10 offset:32768
    ds_read_b64_tr_b16 v[112:113], v14 offset:36864
    ds_read_b64_tr_b16 v[114:115], v14 offset:37376
    buffer_load_dwordx4 v5, s[4:7], s34 offen offset:1024 lds
    v_mfma_f32_32x32x16_bf16 v[48:63], v[124:127], v[172:175], v[48:63]
    ds_read_b64_tr_b16 v[116:117], v15 offset:36864
    ds_read_b64_tr_b16 v[118:119], v15 offset:37376
    s_add_u32 m0, s55, 65536
    s_add_u32 s34, s44, 5
    s_and_b32 s34, s34, 7
    s_mul_i32 s34, s34, 229376
    s_add_u32 s34, s34, s64
    buffer_load_dwordx4 v12, s[8:11], s34 offen lds
    s_cmp_lg_u32 s101, 0
    s_cbranch_scc1 Lo_20
    s_lshl_b32 s3, s50, 8
    s_add_u32 s3, s3, 466944
    v_mov_b32 v64, s100
    s_mov_b64 exec, 0x1111
    buffer_store_dword v64, v2, s[56:59], s3 offen sc1
    s_mov_b64 exec, -1
Lo_20:
    s_lshl_b32 s91, s48, 2
    s_add_u32 s91, s91, s90
    s_lshl_b32 s3, s91, 8
    v_add_u32 v19, s3, v19
    s_mul_i32 s91, s91, 112
    s_lshl_b32 s3, s49, 1
    s_add_u32 s3, s3, s67
    s_lshl_b32 s3, s3, 1
    s_add_u32 s91, s91, s3
    s_lshl_b32 s91, s91, 10
    s_add_u32 s91, s91, 4194304
    s_waitcnt lgkmcnt(12)
    v_mfma_f32_32x32x16_bf16 v[32:47], v[96:99], v[176:179], v[32:47]
    ds_read_b128 v[188:191], v11 offset:32768
    ds_read_b64_tr_b16 v[120:121], v14 offset:38912
    ds_read_b64_tr_b16 v[122:123], v14 offset:39424
    s_waitcnt lgkmcnt(13)
    v_mfma_f32_32x32x16_bf16 v[48:63], v[100:103], v[176:179], v[48:63]
    ds_read_b64_tr_b16 v[124:125], v15 offset:38912
    ds_read_b64_tr_b16 v[126:127], v15 offset:39424
    s_add_u32 m0, s55, 73728
    s_nop 0
    buffer_load_dwordx4 v13, s[12:15], s34 offen lds
    s_waitcnt lgkmcnt(12)
    v_mfma_f32_32x32x16_bf16 v[32:47], v[104:107], v[180:183], v[32:47]
    s_waitcnt lgkmcnt(10)
    v_mfma_f32_32x32x16_bf16 v[48:63], v[108:111], v[180:183], v[48:63]
    s_waitcnt vmcnt(4)
    s_waitcnt lgkmcnt(0)
    s_barrier
    v_mfma_f32_32x32x16_bf16 v[32:47], v[112:115], v[184:187], v[32:47]
    ds_read_b128 v[192:195], v8 offset:0
    ds_read_b64_tr_b16 v[96:97], v14 offset:0
    ds_read_b64_tr_b16 v[98:99], v14 offset:512
    ds_read_b64_tr_b16 v[100:101], v15 offset:0
    ds_read_b64_tr_b16 v[102:103], v15 offset:512
    s_add_u32 m0, s54, 32768
    s_add_u32 s34, s44, 6
    s_and_b32 s34, s34, 7
    s_mul_i32 s34, s34, 128
    s_add_u32 s34, s34, s53
    buffer_load_dwordx4 v4, s[4:7], s34 offen lds
    v_mfma_f32_32x32x16_bf16 v[48:63], v[116:119], v[184:187], v[48:63]
    ds_read_b128 v[196:199], v9 offset:0
    ds_read_b64_tr_b16 v[104:105], v14 offset:2048
    ds_read_b64_tr_b16 v[106:107], v14 offset:2560
    ds_read_b64_tr_b16 v[108:109], v15 offset:2048
    ds_read_b64_tr_b16 v[110:111], v15 offset:2560
    v_mfma_f32_32x32x16_bf16 v[32:47], v[120:123], v[188:191], v[32:47]
    ds_read_b128 v[200:203], v10 offset:0
    ds_read_b64_tr_b16 v[112:113], v14 offset:4096
    ds_read_b64_tr_b16 v[114:115], v14 offset:4608
    buffer_load_dwordx4 v5, s[4:7], s34 offen offset:1024 lds
    v_mfma_f32_32x32x16_bf16 v[48:63], v[124:127], v[188:191], v[48:63]
    ds_read_b64_tr_b16 v[116:117], v15 offset:4096
    ds_read_b64_tr_b16 v[118:119], v15 offset:4608
    s_add_u32 m0, s55, 81920
    s_add_u32 s34, s44, 6
    s_and_b32 s34, s34, 7
    s_mul_i32 s34, s34, 229376
    s_add_u32 s34, s34, s64
    buffer_load_dwordx4 v12, s[8:11], s34 offen lds
    s_waitcnt lgkmcnt(12)
    v_mfma_f32_32x32x16_bf16 v[32:47], v[96:99], v[192:195], v[32:47]
    ds_read_b128 v[204:207], v11 offset:0
    ds_read_b64_tr_b16 v[120:121], v14 offset:6144
    ds_read_b64_tr_b16 v[122:123], v14 offset:6656
    s_waitcnt lgkmcnt(13)
    v_mfma_f32_32x32x16_bf16 v[48:63], v[100:103], v[192:195], v[48:63]
    ds_read_b64_tr_b16 v[124:125], v15 offset:6144
    ds_read_b64_tr_b16 v[126:127], v15 offset:6656
    s_add_u32 m0, s55, 90112
    s_nop 0
    buffer_load_dwordx4 v13, s[12:15], s34 offen lds
    s_waitcnt lgkmcnt(12)
    v_mfma_f32_32x32x16_bf16 v[32:47], v[104:107], v[196:199], v[32:47]
    s_waitcnt lgkmcnt(10)
    v_mfma_f32_32x32x16_bf16 v[48:63], v[108:111], v[196:199], v[48:63]
    s_waitcnt vmcnt(4)
    s_waitcnt lgkmcnt(0)
    s_barrier
    v_mfma_f32_32x32x16_bf16 v[32:47], v[112:115], v[200:203], v[32:47]
    ds_read_b128 v[208:211], v8 offset:16384
    ds_read_b64_tr_b16 v[96:97], v14 offset:16384
    ds_read_b64_tr_b16 v[98:99], v14 offset:16896
    ds_read_b64_tr_b16 v[100:101], v15 offset:16384
    ds_read_b64_tr_b16 v[102:103], v15 offset:16896
    s_add_u32 m0, s54, 0
    s_add_u32 s34, s44, 7
    s_and_b32 s34, s34, 7
    s_mul_i32 s34, s34, 128
    s_add_u32 s34, s34, s53
    buffer_load_dwordx4 v4, s[4:7], s34 offen lds
    v_mfma_f32_32x32x16_bf16 v[48:63], v[116:119], v[200:203], v[48:63]
    ds_read_b128 v[212:215], v9 offset:16384
    ds_read_b64_tr_b16 v[104:105], v14 offset:18432
    ds_read_b64_tr_b16 v[106:107], v14 offset:18944
    ds_read_b64_tr_b16 v[108:109], v15 offset:18432
    ds_read_b64_tr_b16 v[110:111], v15 offset:18944
    v_mfma_f32_32x32x16_bf16 v[32:47], v[120:123], v[204:207], v[32:47]
    ds_read_b128 v[216:219], v10 offset:16384
    ds_read_b64_tr_b16 v[112:113], v14 offset:20480
    ds_read_b64_tr_b16 v[114:115], v14 offset:20992
    buffer_load_dwordx4 v5, s[4:7], s34 offen offset:1024 lds
    v_mfma_f32_32x32x16_bf16 v[48:63], v[124:127], v[204:207], v[48:63]
    ds_read_b64_tr_b16 v[116:117], v15 offset:20480
    ds_read_b64_tr_b16 v[118:119], v15 offset:20992
    s_add_u32 m0, s55, 49152
    s_add_u32 s34, s44, 7
    s_and_b32 s34, s34, 7
    s_mul_i32 s34, s34, 229376
    s_add_u32 s34, s34, s64
    buffer_load_dwordx4 v12, s[8:11], s34 offen lds
    s_waitcnt lgkmcnt(12)
    v_mfma_f32_32x32x16_bf16 v[32:47], v[96:99], v[208:211], v[32:47]
    ds_read_b128 v[220:223], v11 offset:16384
    ds_read_b64_tr_b16 v[120:121], v14 offset:22528
    ds_read_b64_tr_b16 v[122:123], v14 offset:23040
    s_waitcnt lgkmcnt(13)
    v_mfma_f32_32x32x16_bf16 v[48:63], v[100:103], v[208:211], v[48:63]
    ds_read_b64_tr_b16 v[124:125], v15 offset:22528
    ds_read_b64_tr_b16 v[126:127], v15 offset:23040
    s_add_u32 m0, s55, 57344
    s_nop 0
    buffer_load_dwordx4 v13, s[12:15], s34 offen lds
    s_waitcnt lgkmcnt(12)
    v_mfma_f32_32x32x16_bf16 v[32:47], v[104:107], v[212:215], v[32:47]
    s_waitcnt lgkmcnt(10)
    v_mfma_f32_32x32x16_bf16 v[48:63], v[108:111], v[212:215], v[48:63]
    s_waitcnt vmcnt(4)
    s_waitcnt lgkmcnt(0)
    s_barrier
    v_mfma_f32_32x32x16_bf16 v[32:47], v[112:115], v[216:219], v[32:47]
    s_add_u32 m0, s55, 146304
    s_add_u32 s37, s36, s55
    buffer_load_dwordx4 v2, s[56:59], s37 offen sc1 lds
    buffer_load_dwordx2 v[28:29], v19, s[56:59], 0 offen sc1
    ds_read_b128 v[224:227], v8 offset:32768
    ds_read_b64_tr_b16 v[96:97], v14 offset:32768
    ds_read_b64_tr_b16 v[98:99], v14 offset:33280
    ds_read_b64_tr_b16 v[100:101], v15 offset:32768
    ds_read_b64_tr_b16 v[102:103], v15 offset:33280
    s_add_u32 m0, s55, 16384
    s_add_u32 s34, s44, 0
    s_and_b32 s34, s34, 7
    s_mul_i32 s34, s34, 229376
    s_add_u32 s34, s34, s64
    s_add_u32 s34, s34, 1792
    buffer_load_dwordx4 v12, s[8:11], s34 offen lds
    v_mfma_f32_32x32x16_bf16 v[48:63], v[116:119], v[216:219], v[48:63]
    ds_read_b128 v[228:231], v9 offset:32768
    ds_read_b64_tr_b16 v[104:105], v14 offset:34816
    ds_read_b64_tr_b16 v[106:107], v14 offset:35328
    ds_read_b64_tr_b16 v[108:109], v15 offset:34816
    ds_read_b64_tr_b16 v[110:111], v15 offset:35328
    v_mfma_f32_32x32x16_bf16 v[32:47], v[120:123], v[220:223], v[32:47]
    ds_read_b128 v[232:235], v10 offset:32768
    ds_read_b64_tr_b16 v[112:113], v14 offset:36864
    ds_read_b64_tr_b16 v[114:115], v14 offset:37376
    s_add_u32 m0, s55, 24576
    s_nop 0
    buffer_load_dwordx4 v13, s[12:15], s34 offen lds
    s_lshl_b32 s37, s67, 12
    s_add_u32 s3, s37, 146304
    v_add_u32 v18, s3, v2
    s_add_u32 s37, s37, s36
    v_mfma_f32_32x32x16_bf16 v[48:63], v[124:127], v[220:223], v[48:63]
    ds_read_b64_tr_b16 v[116:117], v15 offset:36864
    ds_read_b64_tr_b16 v[118:119], v15 offset:37376
    s_add_u32 m0, s55, 65536
    s_add_u32 s34, s44, 1
    s_and_b32 s34, s34, 7
    s_mul_i32 s34, s34, 229376
    s_add_u32 s34, s34, s64
    s_add_u32 s34, s34, 1792
    buffer_load_dwordx4 v12, s[8:11], s34 offen lds
    s_waitcnt lgkmcnt(12)
    v_mfma_f32_32x32x16_bf16 v[32:47], v[96:99], v[224:227], v[32:47]
    ds_read_b128 v[236:239], v11 offset:32768
    ds_read_b64_tr_b16 v[120:121], v14 offset:38912
    ds_read_b64_tr_b16 v[122:123], v14 offset:39424
    s_waitcnt lgkmcnt(13)
    v_mfma_f32_32x32x16_bf16 v[48:63], v[100:103], v[224:227], v[48:63]
    ds_read_b64_tr_b16 v[124:125], v15 offset:38912
    ds_read_b64_tr_b16 v[126:127], v15 offset:39424
    s_add_u32 m0, s55, 73728
    s_nop 0
    buffer_load_dwordx4 v13, s[12:15], s34 offen lds
    s_waitcnt lgkmcnt(12)
    v_mfma_f32_32x32x16_bf16 v[32:47], v[104:107], v[228:231], v[32:47]
    s_waitcnt lgkmcnt(10)
    v_mfma_f32_32x32x16_bf16 v[48:63], v[108:111], v[228:231], v[48:63]
    s_min_u32 s38, s101, 6
    s_lshl3_add_u32 s38, s52, s38
    s_lshl_b32 s38, s38, 10
    s_add_u32 s38, s38, 467968
    v_and_b32 v20, 3, v0
    v_lshlrev_b32 v20, 8, v20
    buffer_load_dword v20, v20, s[56:59], s38 offen sc1
    s_waitcnt vmcnt(6)
    s_waitcnt lgkmcnt(0)
    s_barrier
    ds_read_b128 v[80:83], v18 offset:0
    ds_read_b128 v[84:87], v18 offset:1024
    ds_read_b128 v[88:91], v18 offset:2048
    ds_read_b128 v[4:7], v18 offset:3072
    v_mfma_f32_32x32x16_bf16 v[32:47], v[112:115], v[232:235], v[32:47]
    ds_read_b128 v[240:243], v8 offset:0
    ds_read_b64_tr_b16 v[96:97], v14 offset:0
    ds_read_b64_tr_b16 v[98:99], v14 offset:512
    ds_read_b64_tr_b16 v[100:101], v15 offset:0
    ds_read_b64_tr_b16 v[102:103], v15 offset:512
    s_add_u32 m0, s55, 32768
    s_add_u32 s34, s44, 2
    s_and_b32 s34, s34, 7
    s_mul_i32 s34, s34, 229376
    s_add_u32 s34, s34, s64
    s_add_u32 s34, s34, 1792
    buffer_load_dwordx4 v12, s[8:11], s34 offen lds
    v_mfma_f32_32x32x16_bf16 v[48:63], v[116:119], v[232:235], v[48:63]
    ds_read_b128 v[244:247], v9 offset:0
    ds_read_b64_tr_b16 v[104:105], v14 offset:2048
    ds_read_b64_tr_b16 v[106:107], v14 offset:2560
    ds_read_b64_tr_b16 v[108:109], v15 offset:2048
    ds_read_b64_tr_b16 v[110:111], v15 offset:2560
    v_mfma_f32_32x32x16_bf16 v[32:47], v[120:123], v[236:239], v[32:47]
    ds_read_b128 v[248:251], v10 offset:0
    ds_read_b64_tr_b16 v[112:113], v14 offset:4096
    ds_read_b64_tr_b16 v[114:115], v14 offset:4608
    s_add_u32 m0, s55, 40960
    s_nop 0
    buffer_load_dwordx4 v13, s[12:15], s34 offen lds
    s_waitcnt vmcnt(7)
    v_xor_b32 v29, s100, v29
    s_waitcnt lgkmcnt(15)
    v_xor_b32 v81, s100, v81
    v_xor_b32 v83, s100, v83
    v_xor_b32 v85, s100, v85
    v_xor_b32 v87, s100, v87
    s_waitcnt lgkmcnt(14)
    v_xor_b32 v89, s100, v89
    v_xor_b32 v91, s100, v91
    s_waitcnt lgkmcnt(13)
    v_xor_b32 v5, s100, v5
    v_xor_b32 v7, s100, v7
    v_or3_b32 v3, v29, v81, v83
    v_or3_b32 v3, v3, v85, v87
    v_or3_b32 v3, v3, v89, v91
    v_or3_b32 v3, v3, v5, v7
    v_cmp_ne_u32 vcc, 0, v3
    s_nop 1
    s_cmp_eq_u64 vcc, 0
    s_cbranch_scc1 Lok_21
    s_movk_i32 s3, 20000
Lsp_22:
    s_sleep 4
    buffer_load_dwordx2 v[28:29], v19, s[56:59], 0 offen sc1
    buffer_load_dwordx4 v[80:83], v2, s[56:59], s37 offen offset:0 sc1
    buffer_load_dwordx4 v[84:87], v2, s[56:59], s37 offen offset:1024 sc1
    buffer_load_dwordx4 v[88:91], v2, s[56:59], s37 offen offset:2048 sc1
    buffer_load_dwordx4 v[4:7], v2, s[56:59], s37 offen offset:3072 sc1
    s_waitcnt vmcnt(0)
    v_xor_b32 v29, s100, v29
    v_xor_b32 v81, s100, v81
    v_xor_b32 v83, s100, v83
    v_xor_b32 v85, s100, v85
    v_xor_b32 v87, s100, v87
    v_xor_b32 v89, s100, v89
    v_xor_b32 v91, s100, v91
    v_xor_b32 v5, s100, v5
    v_xor_b32 v7, s100, v7
    v_or3_b32 v3, v29, v81, v83
    v_or3_b32 v3, v3, v85, v87
    v_or3_b32 v3, v3, v89, v91
    v_or3_b32 v3, v3, v5, v7
    v_cmp_ne_u32 vcc, 0, v3
    s_nop 1
    s_cmp_eq_u64 vcc, 0
    s_cbranch_scc1 Lok_21
    s_sub_u32 s3, s3, 1
    s_cbranch_scc0 Lsp_22
Lok_21:
    v_mfma_f32_32x32x16_bf16 v[48:63], v[124:127], v[236:239], v[48:63]
    ds_read_b64_tr_b16 v[116:117], v15 offset:4096
    ds_read_b64_tr_b16 v[118:119], v15 offset:4608
    s_add_u32 m0, s55, 81920
    s_add_u32 s34, s44, 3
    s_and_b32 s34, s34, 7
    s_mul_i32 s34, s34, 229376
    s_add_u32 s34, s34, s64
    s_add_u32 s34, s34, 1792
    buffer_load_dwordx4 v12, s[8:11], s34 offen lds
    v_and_b32 v24, 0xffff, v28
    v_and_b32 v29, 0xffff0000, v28
    v_lshl_or_b32 v24, v28, 16, v24
    v_mul_f32 v30, v29, v29
    v_rcp_f32 v29, v29
    v_mov_b32 v25, v24
    v_mov_b32 v26, v24
    v_mov_b32 v27, v24
    s_waitcnt lgkmcnt(12)
    v_mfma_f32_32x32x16_bf16 v[32:47], v[96:99], v[240:243], v[32:47]
    ds_read_b128 v[252:255], v11 offset:0
    ds_read_b64_tr_b16 v[120:121], v14 offset:6144
    ds_read_b64_tr_b16 v[122:123], v14 offset:6656
    v_mfma_f32_32x32x16_bf16 v[64:79], v[88:91], v[24:27], 0
    v_mul_f32 v28, 0xc0135761, v29
    v_mul_f32 v3, v29, v29
    s_waitcnt lgkmcnt(13)
    v_mfma_f32_32x32x16_bf16 v[48:63], v[100:103], v[240:243], v[48:63]
    ds_read_b64_tr_b16 v[124:125], v15 offset:6144
    ds_read_b64_tr_b16 v[126:127], v15 offset:6656
    s_add_u32 m0, s55, 90112
    s_nop 0
    buffer_load_dwordx4 v13, s[12:15], s34 offen lds
    v_mfma_f32_32x32x16_bf16 v[32:47], v[80:83], v[24:27], v[32:47]
    v_mul_f32 v29, 0x3d372713, v28
    v_mul_f32 v29, v29, v3
    v_mfma_f32_32x32x16_bf16 v[48:63], v[84:87], v[24:27], v[48:63]
    s_waitcnt lgkmcnt(12)
    v_mfma_f32_32x32x16_bf16 v[32:47], v[104:107], v[244:247], v[32:47]
    v_mfma_f32_32x32x16_bf16 v[80:95], v[4:7], v[24:27], 0
    s_waitcnt lgkmcnt(10)
    v_mfma_f32_32x32x16_bf16 v[48:63], v[108:111], v[244:247], v[48:63]
    s_waitcnt vmcnt(4)
    v_cmp_ne_u32 vcc, s100, v20
    s_nop 1
    s_cmp_eq_u64 vcc, 0
    s_cbranch_scc0 Lsl_25
Lok_23:
    s_waitcnt lgkmcnt(0)
    s_barrier
    s_lshl_b32 s38, s101, 10
    s_add_u32 s38, s38, 458752
    s_load_dword s28, s[46:47], s38 offset:0
    s_load_dword s29, s[46:47], s38 offset:256
    s_load_dword s30, s[46:47], s38 offset:512
    s_load_dword s31, s[46:47], s38 offset:768
    v_mfma_f32_32x32x16_bf16 v[32:47], v[112:115], v[248:251], v[32:47]
    ds_read_b64_tr_b16 v[96:97], v16 offset:16384
    ds_read_b64_tr_b16 v[98:99], v16 offset:16896
    ds_read_b64_tr_b16 v[100:101], v17 offset:16384
    ds_read_b64_tr_b16 v[102:103], v17 offset:16896
    s_add_u32 m0, s55, 0
    s_add_u32 s34, s44, 4
    s_and_b32 s34, s34, 7
    s_mul_i32 s34, s34, 229376
    s_add_u32 s34, s34, s64
    s_add_u32 s34, s34, 1792
    buffer_load_dwordx4 v12, s[8:11], s34 offen lds
    v_mfma_f32_32x32x16_bf16 v[48:63], v[116:119], v[248:251], v[48:63]
    ds_read_b64_tr_b16 v[104:105], v16 offset:18432
    ds_read_b64_tr_b16 v[106:107], v16 offset:18944
    ds_read_b64_tr_b16 v[108:109], v17 offset:18432
    ds_read_b64_tr_b16 v[110:111], v17 offset:18944
    s_add_u32 m0, s55, 8192
    s_nop 0
    buffer_load_dwordx4 v13, s[12:15], s34 offen lds
    v_mfma_f32_32x32x16_bf16 v[32:47], v[120:123], v[252:255], v[32:47]
    ds_read_b64_tr_b16 v[112:113], v16 offset:20480
    ds_read_b64_tr_b16 v[114:115], v16 offset:20992
    s_add_u32 m0, s55, 49152
    s_add_u32 s34, s44, 5
    s_and_b32 s34, s34, 7
    s_mul_i32 s34, s34, 229376
    s_add_u32 s34, s34, s64
    s_add_u32 s34, s34, 1792
    buffer_load_dwordx4 v12, s[8:11], s34 offen lds
    v_mfma_f32_32x32x16_bf16 v[48:63], v[124:127], v[252:255], v[48:63]
    ds_read_b64_tr_b16 v[116:117], v17 offset:20480
    ds_read_b64_tr_b16 v[118:119], v17 offset:20992
    s_add_u32 m0, s55, 57344
    s_nop 0
    buffer_load_dwordx4 v13, s[12:15], s34 offen lds
    s_waitcnt lgkmcnt(10)
    v_mfma_f32_32x32x16_bf16 v[64:79], v[96:99], v[128:131], v[64:79]
    ds_read_b64_tr_b16 v[120:121], v16 offset:22528
    ds_read_b64_tr_b16 v[122:123], v16 offset:23040
    s_waitcnt lgkmcnt(10)
    v_mfma_f32_32x32x16_bf16 v[80:95], v[100:103], v[128:131], v[80:95]
    ds_read_b64_tr_b16 v[124:125], v17 offset:22528
    ds_read_b64_tr_b16 v[126:127], v17 offset:23040
    v_mul_f32 v4, v32, v32
    v_mul_f32 v5, v33, v33
    v_mul_f32 v6, v34, v34
    v_mul_f32 v7, v35, v35
    v_fma_f32 v4, v4, v29, v28
    v_fma_f32 v5, v5, v29, v28
    v_fma_f32 v6, v6, v29, v28
    s_waitcnt lgkmcnt(10)
    v_mfma_f32_32x32x16_bf16 v[64:79], v[104:107], v[132:135], v[64:79]
    ds_read_b64_tr_b16 v[96:97], v14 offset:16384
    ds_read_b64_tr_b16 v[98:99], v14 offset:16896
    v_fma_f32 v7, v7, v29, v28
    v_mul_f32 v4, v4, v32
    v_mul_f32 v5, v5, v33
    v_mul_f32 v6, v6, v34
    v_mul_f32 v7, v7, v35
    v_exp_f32 v4, v4
    s_waitcnt lgkmcnt(10)
    v_mfma_f32_32x32x16_bf16 v[80:95], v[108:111], v[132:135], v[80:95]
    ds_read_b64_tr_b16 v[100:101], v15 offset:16384
    ds_read_b64_tr_b16 v[102:103], v15 offset:16896
    v_mul_f32 v40, v32, v40
    v_exp_f32 v5, v5
    v_mul_f32 v41, v33, v41
    v_exp_f32 v6, v6
    s_waitcnt lgkmcnt(10)
    v_mfma_f32_32x32x16_bf16 v[64:79], v[112:115], v[136:139], v[64:79]
    ds_read_b64_tr_b16 v[104:105], v14 offset:18432
    ds_read_b64_tr_b16 v[106:107], v14 offset:18944
    s_waitcnt lgkmcnt(0)
    s_xor_b32 s28, s28, s100
    s_xor_b32 s29, s29, s100
    s_xor_b32 s30, s30, s100
    s_xor_b32 s31, s31, s100
    s_or_b32 s28, s28, s29
    s_or_b32 s28, s28, s30
    s_or_b32 s28, s28, s31
    s_cbranch_scc1 Lsl_28
Lok_26:
    v_mul_f32 v42, v34, v42
    v_exp_f32 v7, v7
    v_mul_f32 v43, v35, v43
    v_fma_f32 v4, v4, v30, v30
    v_lshrrev_b32 v3, 2, v0
    v_lshlrev_b32 v3, 14, v3
    v_and_b32 v24, 2, v0
    v_lshl_or_b32 v3, v24, 5, v3
    v_and_b32 v24, 1, v0
    v_lshl_or_b32 v3, v24, 4, v3
    buffer_load_dwordx4 v[128:131], v2, s[56:59], s65 offen offset:0 sc1
    v_mfma_f32_32x32x16_bf16 v[80:95], v[116:119], v[136:139], v[80:95]
    ds_read_b64_tr_b16 v[108:109], v15 offset:18432
    ds_read_b64_tr_b16 v[110:111], v15 offset:18944
    v_fma_f32 v5, v5, v30, v30
    v_fma_f32 v6, v6, v30, v30
    v_fma_f32 v7, v7, v30, v30
    v_rcp_f32 v4, v4
    v_rcp_f32 v5, v5
    buffer_load_dwordx4 v[132:135], v2, s[56:59], s65 offen offset:1024 sc1
    v_mfma_f32_32x32x16_bf16 v[64:79], v[120:123], v[140:143], v[64:79]
    ds_read_b64_tr_b16 v[112:113], v14 offset:20480
    ds_read_b64_tr_b16 v[114:115], v14 offset:20992
    v_rcp_f32 v6, v6
    v_rcp_f32 v7, v7
    v_mul_f32 v40, v40, v4
    v_mul_f32 v41, v41, v5
    s_lshl_b32 s3, s101, 18
    s_lshr_b32 s98, s50, 1
    s_lshl_b32 s98, s98, 7
    s_add_u32 s3, s3, s98
    s_and_b32 s98, s50, 1
    s_lshl_b32 s98, s98, 5
    s_add_u32 s3, s3, s98
    s_add_u32 s3, s3, 0x200000
    buffer_load_dwordx4 v[24:27], v3, s[56:59], s3 offen sc1
    v_mfma_f32_32x32x16_bf16 v[80:95], v[124:127], v[140:143], v[80:95]
    ds_read_b64_tr_b16 v[116:117], v15 offset:20480
    ds_read_b64_tr_b16 v[118:119], v15 offset:20992
    v_mul_f32 v42, v42, v6
    v_mul_f32 v43, v43, v7
    v_cvt_pk_bf16_f32 v32, v40, v41
    v_cvt_pk_bf16_f32 v33, v42, v43
    v_mul_f32 v4, v36, v36
    v_mul_f32 v5, v37, v37
    v_mfma_f32_32x32x16_bf16 v[64:79], v[96:99], v[144:147], v[64:79]
    ds_read_b64_tr_b16 v[120:121], v14 offset:22528
    ds_read_b64_tr_b16 v[122:123], v14 offset:23040
    v_mul_f32 v6, v38, v38
    v_mul_f32 v7, v39, v39
    v_fma_f32 v4, v4, v29, v28
    v_fma_f32 v5, v5, v29, v28
    v_fma_f32 v6, v6, v29, v28
    v_fma_f32 v7, v7, v29, v28
    v_mfma_f32_32x32x16_bf16 v[80:95], v[100:103], v[144:147], v[80:95]
    ds_read_b64_tr_b16 v[124:125], v15 offset:22528
    ds_read_b64_tr_b16 v[126:127], v15 offset:23040
    v_mul_f32 v4, v4, v36
    v_mul_f32 v5, v5, v37
    v_mul_f32 v6, v6, v38
    v_mul_f32 v7, v7, v39
    v_exp_f32 v4, v4
    v_mfma_f32_32x32x16_bf16 v[64:79], v[104:107], v[148:151], v[64:79]
    v_mul_f32 v44, v36, v44
    v_exp_f32 v5, v5
    v_mul_f32 v45, v37, v45
    v_exp_f32 v6, v6
    v_mul_f32 v46, v38, v46
    s_waitcnt lgkmcnt(8)
    v_mfma_f32_32x32x16_bf16 v[80:95], v[108:111], v[148:151], v[80:95]
    v_exp_f32 v7, v7
    v_mul_f32 v47, v39, v47
    v_fma_f32 v4, v4, v30, v30
    v_fma_f32 v5, v5, v30, v30
    v_fma_f32 v6, v6, v30, v30
    s_waitcnt vmcnt(7)
    s_waitcnt lgkmcnt(0)
    s_barrier
    v_mfma_f32_32x32x16_bf16 v[64:79], v[112:115], v[152:155], v[64:79]
    ds_read_b64_tr_b16 v[96:97], v16 offset:32768
    ds_read_b64_tr_b16 v[98:99], v16 offset:33280
    ds_read_b64_tr_b16 v[100:101], v17 offset:32768
    ds_read_b64_tr_b16 v[102:103], v17 offset:33280
    v_fma_f32 v7, v7, v30, v30
    v_rcp_f32 v4, v4
    v_rcp_f32 v5, v5
    v_rcp_f32 v6, v6
    s_add_u32 m0, s55, 16384
    s_add_u32 s34, s44, 6
    s_and_b32 s34, s34, 7
    s_mul_i32 s34, s34, 229376
    s_add_u32 s34, s34, s64
    s_add_u32 s34, s34, 1792
    buffer_load_dwordx4 v12, s[8:11], s34 offen lds
    v_mfma_f32_32x32x16_bf16 v[80:95], v[116:119], v[152:155], v[80:95]
    ds_read_b64_tr_b16 v[104:105], v16 offset:34816
    ds_read_b64_tr_b16 v[106:107], v16 offset:35328
    ds_read_b64_tr_b16 v[108:109], v17 offset:34816
    ds_read_b64_tr_b16 v[110:111], v17 offset:35328
    v_rcp_f32 v7, v7
    v_mul_f32 v44, v44, v4
    v_mul_f32 v45, v45, v5
    v_mul_f32 v46, v46, v6
    s_add_u32 m0, s55, 24576
    s_nop 0
    buffer_load_dwordx4 v13, s[12:15], s34 offen lds
    v_mfma_f32_32x32x16_bf16 v[64:79], v[120:123], v[156:159], v[64:79]
    ds_read_b64_tr_b16 v[112:113], v16 offset:36864
    ds_read_b64_tr_b16 v[114:115], v16 offset:37376
    v_mul_f32 v47, v47, v7
    v_cvt_pk_bf16_f32 v34, v44, v45
    v_cvt_pk_bf16_f32 v35, v46, v47
    v_mul_f32 v4, v48, v48
    v_mul_f32 v5, v49, v49
    v_mul_f32 v6, v50, v50
    v_mul_f32 v7, v51, v51
    s_add_u32 m0, s55, 65536
    s_add_u32 s34, s44, 7
    s_and_b32 s34, s34, 7
    s_mul_i32 s34, s34, 229376
    s_add_u32 s34, s34, s64
    s_add_u32 s34, s34, 1792
    buffer_load_dwordx4 v12, s[8:11], s34 offen lds
    v_mfma_f32_32x32x16_bf16 v[80:95], v[124:127], v[156:159], v[80:95]
    ds_read_b64_tr_b16 v[116:117], v17 offset:36864
    ds_read_b64_tr_b16 v[118:119], v17 offset:37376
    v_fma_f32 v4, v4, v29, v28
    v_fma_f32 v5, v5, v29, v28
    v_fma_f32 v6, v6, v29, v28
    v_fma_f32 v7, v7, v29, v28
    v_mul_f32 v4, v4, v48
    v_mul_f32 v5, v5, v49
    s_add_u32 m0, s55, 73728
    s_nop 0
    buffer_load_dwordx4 v13, s[12:15], s34 offen lds
    s_waitcnt lgkmcnt(10)
    v_mfma_f32_32x32x16_bf16 v[64:79], v[96:99], v[160:163], v[64:79]
    ds_read_b64_tr_b16 v[120:121], v16 offset:38912
    ds_read_b64_tr_b16 v[122:123], v16 offset:39424
    v_mul_f32 v6, v6, v50
    v_mul_f32 v7, v7, v51
    v_exp_f32 v4, v4
    v_mul_f32 v56, v48, v56
    v_exp_f32 v5, v5
    s_waitcnt lgkmcnt(10)
    v_mfma_f32_32x32x16_bf16 v[80:95], v[100:103], v[160:163], v[80:95]
    ds_read_b64_tr_b16 v[124:125], v17 offset:38912
    ds_read_b64_tr_b16 v[126:127], v17 offset:39424
    v_mul_f32 v57, v49, v57
    v_exp_f32 v6, v6
    v_mul_f32 v58, v50, v58
    v_exp_f32 v7, v7
    buffer_store_dwordx4 v[32:35], v2, s[56:59], s91 offen offset:0 sc1
    s_waitcnt lgkmcnt(10)
    v_mfma_f32_32x32x16_bf16 v[64:79], v[104:107], v[164:167], v[64:79]
    ds_read_b64_tr_b16 v[96:97], v14 offset:32768
    ds_read_b64_tr_b16 v[98:99], v14 offset:33280
    v_mul_f32 v59, v51, v59
    v_fma_f32 v4, v4, v30, v30
    v_fma_f32 v5, v5, v30, v30
    v_fma_f32 v6, v6, v30, v30
    v_fma_f32 v7, v7, v30, v30
    s_waitcnt lgkmcnt(10)
    v_mfma_f32_32x32x16_bf16 v[80:95], v[108:111], v[164:167], v[80:95]
    ds_read_b64_tr_b16 v[100:101], v15 offset:32768
    ds_read_b64_tr_b16 v[102:103], v15 offset:33280
    v_rcp_f32 v4, v4
    v_rcp_f32 v5, v5
    v_rcp_f32 v6, v6
    v_rcp_f32 v7, v7
    buffer_load_dwordx4 v[136:139], v2, s[56:59], s65 offen offset:2048 sc1
    s_waitcnt lgkmcnt(10)
    v_mfma_f32_32x32x16_bf16 v[64:79], v[112:115], v[168:171], v[64:79]
    ds_read_b64_tr_b16 v[104:105], v14 offset:34816
    ds_read_b64_tr_b16 v[106:107], v14 offset:35328
    v_mul_f32 v56, v56, v4
    v_mul_f32 v57, v57, v5
    v_mul_f32 v58, v58, v6
    v_mul_f32 v59, v59, v7
    v_cvt_pk_bf16_f32 v48, v56, v57
    buffer_load_dwordx4 v[140:143], v2, s[56:59], s65 offen offset:3072 sc1
    s_waitcnt lgkmcnt(10)
    v_mfma_f32_32x32x16_bf16 v[80:95], v[116:119], v[168:171], v[80:95]
    ds_read_b64_tr_b16 v[108:109], v15 offset:34816
    ds_read_b64_tr_b16 v[110:111], v15 offset:35328
    v_cvt_pk_bf16_f32 v49, v58, v59
    v_mul_f32 v4, v52, v52
    v_mul_f32 v5, v53, v53
    v_mul_f32 v6, v54, v54
    v_mul_f32 v7, v55, v55
    v_fma_f32 v4, v4, v29, v28
    s_waitcnt lgkmcnt(10)
    v_mfma_f32_32x32x16_bf16 v[64:79], v[120:123], v[172:175], v[64:79]
    ds_read_b64_tr_b16 v[112:113], v14 offset:36864
    ds_read_b64_tr_b16 v[114:115], v14 offset:37376
    v_fma_f32 v5, v5, v29, v28
    v_fma_f32 v6, v6, v29, v28
    v_fma_f32 v7, v7, v29, v28
    v_mul_f32 v4, v4, v52
    v_mul_f32 v5, v5, v53
    v_mul_f32 v6, v6, v54
    s_add_u32 s35, s65, 4096
    buffer_load_dwordx4 v[144:147], v2, s[56:59], s35 offen offset:0 sc1
    s_waitcnt lgkmcnt(10)
    v_mfma_f32_32x32x16_bf16 v[80:95], v[124:127], v[172:175], v[80:95]
    ds_read_b64_tr_b16 v[116:117], v15 offset:36864
    ds_read_b64_tr_b16 v[118:119], v15 offset:37376
    v_mul_f32 v7, v7, v55
    v_exp_f32 v4, v4
    v_mul_f32 v60, v52, v60
    v_exp_f32 v5, v5
    v_mul_f32 v61, v53, v61
    s_add_u32 s35, s65, 4096
    buffer_load_dwordx4 v[148:151], v2, s[56:59], s35 offen offset:1024 sc1
    s_waitcnt lgkmcnt(10)
    v_mfma_f32_32x32x16_bf16 v[64:79], v[96:99], v[176:179], v[64:79]
    ds_read_b64_tr_b16 v[120:121], v14 offset:38912
    ds_read_b64_tr_b16 v[122:123], v14 offset:39424
    v_exp_f32 v6, v6
    v_mul_f32 v62, v54, v62
    v_exp_f32 v7, v7
    v_mul_f32 v63, v55, v63
    s_waitcnt lgkmcnt(10)
    v_mfma_f32_32x32x16_bf16 v[80:95], v[100:103], v[176:179], v[80:95]
    ds_read_b64_tr_b16 v[124:125], v15 offset:38912
    ds_read_b64_tr_b16 v[126:127], v15 offset:39424
    v_fma_f32 v4, v4, v30, v30
    v_fma_f32 v5, v5, v30, v30
    v_fma_f32 v6, v6, v30, v30
    v_fma_f32 v7, v7, v30, v30
    v_rcp_f32 v4, v4
    s_add_u32 s35, s65, 4096
    buffer_load_dwordx4 v[152:155], v2, s[56:59], s35 offen offset:2048 sc1
    s_waitcnt lgkmcnt(10)
    v_mfma_f32_32x32x16_bf16 v[64:79], v[104:107], v[180:183], v[64:79]
    v_rcp_f32 v5, v5
    v_rcp_f32 v6, v6
    v_rcp_f32 v7, v7
    s_add_u32 s35, s65, 4096
    buffer_load_dwordx4 v[156:159], v2, s[56:59], s35 offen offset:3072 sc1
    v_and_b32 v22, 1, v0
    v_mul_u32_u24 v22, 15544, v22
    v_lshl_add_u32 v3, v0, 3, v22
    s_lshl_b32 s3, s101, 9
    s_add_u32 s3, s3, 116240
    v_add_u32 v3, s3, v3
    s_waitcnt lgkmcnt(8)
    v_mfma_f32_32x32x16_bf16 v[80:95], v[108:111], v[180:183], v[80:95]
    v_mul_f32 v60, v60, v4
    v_mul_f32 v61, v61, v5
    v_mul_f32 v62, v62, v6
    v_mul_f32 v63, v63, v7
    v_cvt_pk_bf16_f32 v50, v60, v61
    v_cvt_pk_bf16_f32 v51, v62, v63
    s_waitcnt vmcnt(11)
    ds_write_b128 v3, v[24:27] offset:16
    s_waitcnt vmcnt(7)
    s_waitcnt lgkmcnt(0)
    s_barrier
    v_mfma_f32_32x32x16_bf16 v[64:79], v[112:115], v[184:187], v[64:79]
    ds_read_b64_tr_b16 v[96:97], v16 offset:0
    ds_read_b64_tr_b16 v[98:99], v16 offset:512
    ds_read_b64_tr_b16 v[100:101], v16 offset:2048
    ds_read_b64_tr_b16 v[102:103], v16 offset:2560
    buffer_store_dwordx4 v[48:51], v2, s[56:59], s91 offen offset:1024 sc1
    s_cmp_ge_u32 s101, 6
    s_cbranch_scc1 Lo_29
    ds_read_b128 v[32:35], v3
    v_lshlrev_b32 v44, 16, v24
    v_and_b32 v45, 0xffff0000, v24
Lo_29:
    v_mfma_f32_32x32x16_bf16 v[80:95], v[116:119], v[184:187], v[80:95]
    ds_read_b64_tr_b16 v[104:105], v16 offset:4096
    ds_read_b64_tr_b16 v[106:107], v16 offset:4608
    ds_read_b64_tr_b16 v[108:109], v16 offset:6144
    ds_read_b64_tr_b16 v[110:111], v16 offset:6656
    s_cmp_ge_u32 s101, 6
    s_cbranch_scc1 Lo_30
    v_lshlrev_b32 v46, 16, v25
    v_and_b32 v47, 0xffff0000, v25
    v_lshlrev_b32 v48, 16, v26
    v_and_b32 v49, 0xffff0000, v26
    s_waitcnt lgkmcnt(4)
    v_lshlrev_b32 v36, 16, v32
    v_and_b32 v37, 0xffff0000, v32
Lo_30:
    v_mfma_f32_32x32x16_bf16 v[64:79], v[120:123], v[188:191], v[64:79]
    ds_read_b64_tr_b16 v[112:113], v14 offset:0
    ds_read_b64_tr_b16 v[114:115], v14 offset:512
    s_add_u32 s35, s65, 8192
    buffer_load_dwordx4 v[160:163], v2, s[56:59], s35 offen offset:0 sc1
    s_cmp_ge_u32 s101, 6
    s_cbranch_scc1 Lo_31
    s_waitcnt lgkmcnt(6)
    v_lshlrev_b32 v38, 16, v33
    v_add_f32 v37, v37, v36
    v_and_b32 v39, 0xffff0000, v33
    v_add_f32 v38, v38, v37
    v_lshlrev_b32 v40, 16, v34
Lo_31:
    v_mfma_f32_32x32x16_bf16 v[80:95], v[124:127], v[188:191], v[80:95]
    ds_read_b64_tr_b16 v[116:117], v14 offset:2048
    ds_read_b64_tr_b16 v[118:119], v14 offset:2560
    s_add_u32 s35, s65, 8192
    buffer_load_dwordx4 v[164:167], v2, s[56:59], s35 offen offset:1024 sc1
    s_cmp_ge_u32 s101, 6
    s_cbranch_scc1 Lo_32
    v_add_f32 v39, v39, v38
    s_waitcnt lgkmcnt(8)
    v_and_b32 v41, 0xffff0000, v34
    v_add_f32 v40, v40, v39
    v_lshlrev_b32 v42, 16, v35
    v_add_f32 v41, v41, v40
Lo_32:
    s_waitcnt lgkmcnt(10)
    v_mfma_f32_32x32x16_bf16 v[64:79], v[96:99], v[192:195], v[64:79]
    ds_read_b64_tr_b16 v[120:121], v14 offset:4096
    ds_read_b64_tr_b16 v[122:123], v14 offset:4608
    s_cmp_ge_u32 s101, 6
    s_cbranch_scc1 Lo_33
    s_waitcnt lgkmcnt(10)
    v_and_b32 v43, 0xffff0000, v35
    v_add_f32 v42, v42, v41
    v_add_f32 v43, v43, v42
    v_add_f32 v44, v44, v43
    v_add_f32 v45, v45, v44
Lo_33:
    s_waitcnt lgkmcnt(10)
    v_mfma_f32_32x32x16_bf16 v[64:79], v[100:103], v[196:199], v[64:79]
    ds_read_b64_tr_b16 v[124:125], v14 offset:6144
    ds_read_b64_tr_b16 v[126:127], v14 offset:6656
    s_cmp_ge_u32 s101, 6
    s_cbranch_scc1 Lo_34
    v_add_f32 v46, v46, v45
    v_add_f32 v47, v47, v46
    v_add_f32 v48, v48, v47
    v_add_f32 v49, v49, v48
    v_sub_f32 v52, v41, v38
Lo_34:
    s_waitcnt lgkmcnt(10)
    v_mfma_f32_32x32x16_bf16 v[64:79], v[104:107], v[200:203], v[64:79]
    ds_read_b64_tr_b16 v[96:97], v16 offset:16384
    ds_read_b64_tr_b16 v[98:99], v16 offset:16896
    s_add_u32 s35, s65, 8192
    buffer_load_dwordx4 v[168:171], v2, s[56:59], s35 offen offset:2048 sc1
    s_cmp_ge_u32 s101, 6
    s_cbranch_scc1 Lo_35
    v_sub_f32 v53, v42, v39
    v_sub_f32 v54, v43, v40
    v_sub_f32 v55, v44, v41
    v_sub_f32 v56, v45, v42
    v_sub_f32 v57, v46, v43
Lo_35:
    s_waitcnt lgkmcnt(10)
    v_mfma_f32_32x32x16_bf16 v[64:79], v[108:111], v[204:207], v[64:79]
    ds_read_b64_tr_b16 v[100:101], v16 offset:18432
    ds_read_b64_tr_b16 v[102:103], v16 offset:18944
    s_add_u32 s35, s65, 8192
    buffer_load_dwordx4 v[172:175], v2, s[56:59], s35 offen offset:3072 sc1
    s_cmp_ge_u32 s101, 6
    s_cbranch_scc1 Lo_36
    v_sub_f32 v58, v47, v44
    v_sub_f32 v59, v48, v45
    v_cvt_pk_bf16_f32 v60, v52, v53
    v_cvt_pk_bf16_f32 v61, v54, v55
    v_cvt_pk_bf16_f32 v62, v56, v57
Lo_36:
    s_waitcnt lgkmcnt(10)
    v_mfma_f32_32x32x16_bf16 v[64:79], v[112:115], v[208:211], v[64:79]
    ds_read_b64_tr_b16 v[104:105], v16 offset:20480
    ds_read_b64_tr_b16 v[106:107], v16 offset:20992
    s_cmp_ge_u32 s101, 6
    s_cbranch_scc1 Lo_37
    v_cvt_pk_bf16_f32 v63, v58, v59
    ds_write_b128 v3, v[60:63] offset:4144
    v_sub_f32 v52, v42, v37
    v_sub_f32 v53, v43, v38
    v_sub_f32 v54, v44, v39
Lo_37:
    s_waitcnt vmcnt(4)
    v_mov_b32 v12, 1
    v_mov_b32 v13, 130720
    s_mov_b64 exec, 1
    ds_add_rtn_u32 v12, v13, v12
    s_mov_b64 exec, -1
    s_waitcnt lgkmcnt(11)
    v_mfma_f32_32x32x16_bf16 v[64:79], v[116:119], v[212:215], v[64:79]
    ds_read_b64_tr_b16 v[108:109], v16 offset:22528
    ds_read_b64_tr_b16 v[110:111], v16 offset:23040
    s_cmp_ge_u32 s101, 6
    s_cbranch_scc1 Lo_38
    v_sub_f32 v55, v45, v40
    v_sub_f32 v56, v46, v41
    v_sub_f32 v57, v47, v42
    v_sub_f32 v58, v48, v43
    v_sub_f32 v59, v49, v44
Lo_38:
    s_waitcnt lgkmcnt(11)
    v_mfma_f32_32x32x16_bf16 v[64:79], v[120:123], v[216:219], v[64:79]
    ds_read_b64_tr_b16 v[112:113], v14 offset:16384
    ds_read_b64_tr_b16 v[114:115], v14 offset:16896
    s_add_u32 s35, s65, 12288
    buffer_load_dwordx4 v[176:179], v2, s[56:59], s35 offen offset:0 sc1
    s_cmp_ge_u32 s101, 6
    s_cbranch_scc1 Lo_39
    v_cvt_pk_bf16_f32 v32, v52, v53
    v_cvt_pk_bf16_f32 v33, v54, v55
    v_cvt_pk_bf16_f32 v34, v56, v57
    v_cvt_pk_bf16_f32 v35, v58, v59
    ds_write_b128 v3, v[32:35] offset:7248
Lo_39:
    s_waitcnt lgkmcnt(4)
    v_readfirstlane_b32 s3, v12
    s_nop 0
    s_cmp_lg_u32 s3, 7
    s_cbranch_scc1 Lo_40
    s_lshl_b32 s3, s48, 4
    s_add_u32 s3, s3, s49
    s_lshl_b32 s3, s3, 8
    s_add_u32 s3, s3, 262144
    v_mov_b32 v13, s100
    s_mov_b64 exec, 0x1111
    buffer_store_dword v13, v2, s[56:59], s3 offen sc1
    s_mov_b64 exec, -1
Lo_40:
    v_mfma_f32_32x32x16_bf16 v[64:79], v[124:127], v[220:223], v[64:79]
    ds_read_b64_tr_b16 v[116:117], v14 offset:18432
    ds_read_b64_tr_b16 v[118:119], v14 offset:18944
    s_add_u32 s35, s65, 12288
    buffer_load_dwordx4 v[180:183], v2, s[56:59], s35 offen offset:1024 sc1
    s_cmp_ge_u32 s101, 4
    s_cbranch_scc1 Lo_41
    v_lshlrev_b32 v50, 16, v27
    v_and_b32 v51, 0xffff0000, v27
    v_add_f32 v50, v50, v49
    v_add_f32 v51, v51, v50
    v_sub_f32 v52, v43, v36
    v_sub_f32 v53, v44, v37
Lo_41:
    v_mfma_f32_32x32x16_bf16 v[64:79], v[96:99], v[224:227], v[64:79]
    ds_read_b64_tr_b16 v[120:121], v14 offset:20480
    ds_read_b64_tr_b16 v[122:123], v14 offset:20992
    s_cmp_ge_u32 s101, 4
    s_cbranch_scc1 Lo_42
    v_sub_f32 v54, v45, v38
    v_sub_f32 v55, v46, v39
    v_sub_f32 v56, v47, v40
    v_sub_f32 v57, v48, v41
    v_sub_f32 v58, v49, v42
    v_sub_f32 v59, v50, v43
Lo_42:
    v_mfma_f32_32x32x16_bf16 v[64:79], v[100:103], v[228:231], v[64:79]
    ds_read_b64_tr_b16 v[124:125], v14 offset:22528
    ds_read_b64_tr_b16 v[126:127], v14 offset:23040
    s_cmp_ge_u32 s101, 4
    s_cbranch_scc1 Lo_43
    v_cvt_pk_bf16_f32 v60, v52, v53
    v_cvt_pk_bf16_f32 v61, v54, v55
    v_cvt_pk_bf16_f32 v62, v56, v57
    v_cvt_pk_bf16_f32 v63, v58, v59
    ds_write_b128 v3, v[60:63] offset:10352
    v_sub_f32 v53, v45, v36
Lo_43:
    v_mfma_f32_32x32x16_bf16 v[64:79], v[104:107], v[232:235], v[64:79]
    s_add_u32 s35, s65, 114688
    buffer_load_dwordx4 v[184:187], v2, s[56:59], s35 offen offset:0 sc1
    s_cmp_ge_u32 s101, 4
    s_cbranch_scc1 Lo_44
    v_sub_f32 v54, v46, v37
    v_sub_f32 v55, v47, v38
    v_sub_f32 v56, v48, v39
    v_sub_f32 v57, v49, v40
    v_sub_f32 v58, v50, v41
    v_sub_f32 v59, v51, v42
Lo_44:
    s_waitcnt lgkmcnt(8)
    v_mfma_f32_32x32x16_bf16 v[64:79], v[108:111], v[236:239], v[64:79]
    s_add_u32 s35, s65, 114688
    buffer_load_dwordx4 v[188:191], v2, s[56:59], s35 offen offset:1024 sc1
    s_cmp_ge_u32 s101, 4
    s_cbranch_scc1 Lo_45
    v_cvt_pk_bf16_f32 v32, v44, v53
    v_cvt_pk_bf16_f32 v33, v54, v55
    v_cvt_pk_bf16_f32 v34, v56, v57
    v_cvt_pk_bf16_f32 v35, v58, v59
    ds_write_b128 v3, v[32:35] offset:12432
Lo_45:
    s_mul_i32 s53, s51, 229376
    s_mul_i32 s3, s101, 7168
    s_add_u32 s53, s53, s3
    s_add_u32 s53, s53, 4194304
    s_add_u32 s91, s91, 57344
    s_waitcnt lgkmcnt(0)
    s_barrier
    v_mfma_f32_32x32x16_bf16 v[64:79], v[112:115], v[240:243], v[64:79]
    ds_read_b64_tr_b16 v[96:97], v17 offset:0
    ds_read_b64_tr_b16 v[98:99], v17 offset:512
    ds_read_b64_tr_b16 v[100:101], v17 offset:2048
    ds_read_b64_tr_b16 v[102:103], v17 offset:2560
    s_and_b32 s68, s101, 1
    s_lshr_b32 s69, s101, 1
    s_xor_b32 s3, s69, 3
    s_sub_u32 s69, s69, 2
    s_cselect_b32 s69, s3, s69
    v_bfe_u32 v32, v0, 2, 2
    v_mul_u32_u24 v32, 2112, v32
    v_and_b32 v33, 3, v0
    v_mfma_f32_32x32x16_bf16 v[64:79], v[116:119], v[244:247], v[64:79]
    ds_read_b64_tr_b16 v[104:105], v17 offset:4096
    ds_read_b64_tr_b16 v[106:107], v17 offset:4608
    ds_read_b64_tr_b16 v[108:109], v17 offset:6144
    ds_read_b64_tr_b16 v[110:111], v17 offset:6656
    v_lshl_add_u32 v32, v33, 3, v32
    s_mul_i32 s3, s68, 8448
    s_add_u32 s3, s3, 98304
    v_add_u32 v32, s3, v32
    v_and_b32 v33, 48, v0
    v_mfma_f32_32x32x16_bf16 v[64:79], v[120:123], v[248:251], v[64:79]
    ds_read_b64_tr_b16 v[112:113], v15 offset:0
    ds_read_b64_tr_b16 v[114:115], v15 offset:512
    s_add_u32 s35, s65, 122880
    buffer_load_dwordx4 v[8:11], v2, s[56:59], s35 offen offset:2048 sc1
    v_sub_u32 v18, v32, v33
    v_mad_u32_u24 v19, v33, 6, v32
    v_lshrrev_b32 v34, 5, v0
    v_mfma_f32_32x32x16_bf16 v[64:79], v[124:127], v[252:255], v[64:79]
    ds_read_b64_tr_b16 v[116:117], v15 offset:2048
    ds_read_b64_tr_b16 v[118:119], v15 offset:2560
    s_add_u32 s35, s65, 122880
    buffer_load_dwordx4 v[24:27], v2, s[56:59], s35 offen offset:3072 sc1
    v_and_b32 v35, 16, v0
    s_movk_i32 s3, 152
    v_mad_u32_u24 v21, v34, s3, v32
    v_lshrrev_b32 v36, 1, v35
    s_waitcnt lgkmcnt(10)
    v_mfma_f32_32x32x16_bf16 v[80:95], v[96:99], v[192:195], v[80:95]
    ds_read_b64_tr_b16 v[120:121], v15 offset:4096
    ds_read_b64_tr_b16 v[122:123], v15 offset:4608
    v_sub_u32 v21, v21, v36
    v_and_b32 v36, 15, v0
    v_lshl_add_u32 v1, v36, 5, v33
    s_mul_i32 s3, s68, 15552
    s_lshl_b32 s98, s69, 10
    s_add_u32 s3, s3, s98
    s_add_u32 s3, s3, 114192
    v_add_u32 v1, s3, v1
    s_setprio 3
    s_waitcnt lgkmcnt(10)
    v_mfma_f32_32x32x16_bf16 v[80:95], v[100:103], v[196:199], v[80:95]
    ds_read_b64_tr_b16 v[124:125], v15 offset:6144
    ds_read_b64_tr_b16 v[126:127], v15 offset:6656
    s_mul_i32 s3, s68, 15552
    s_lshl_b32 s98, s69, 10
    s_add_u32 s3, s3, s98
    s_add_u32 s3, s3, 118336
    v_lshl_add_u32 v22, v36, 3, s3
    v_mul_f32 v4, v64, v64
    v_mul_f32 v5, v65, v65
    v_mul_f32 v6, v66, v66
    v_mul_f32 v7, v67, v67
    v_fma_f32 v4, v4, v29, v28
    v_fma_f32 v5, v5, v29, v28
    s_waitcnt lgkmcnt(10)
    v_mfma_f32_32x32x16_bf16 v[80:95], v[104:107], v[200:203], v[80:95]
    ds_read_b64_tr_b16 v[96:97], v17 offset:16384
    ds_read_b64_tr_b16 v[98:99], v17 offset:16896
    s_add_u32 s35, s65, 114688
    buffer_load_dwordx4 v[192:195], v2, s[56:59], s35 offen offset:2048 sc1
    v_sub_u32 v22, v22, v35
    s_movk_i32 s3, 3096
    v_mad_u32_u24 v22, v34, s3, v22
    v_and_b32 v36, 31, v0
    v_fma_f32 v6, v6, v29, v28
    v_fma_f32 v7, v7, v29, v28
    v_mul_f32 v4, v4, v64
    v_mul_f32 v5, v5, v65
    v_mul_f32 v6, v6, v66
    v_mul_f32 v7, v7, v67
    s_waitcnt lgkmcnt(10)
    v_mfma_f32_32x32x16_bf16 v[80:95], v[108:111], v[204:207], v[80:95]
    ds_read_b64_tr_b16 v[100:101], v17 offset:18432
    ds_read_b64_tr_b16 v[102:103], v17 offset:18944
    s_add_u32 s35, s65, 114688
    buffer_load_dwordx4 v[196:199], v2, s[56:59], s35 offen offset:3072 sc1
    s_mul_i32 s3, s68, 15552
    s_lshl_b32 s98, s69, 10
    s_add_u32 s3, s3, s98
    s_add_u32 s3, s3, 123512
    v_lshl_add_u32 v23, v36, 3, s3
    s_movk_i32 s3, 2064
    v_mad_u32_u24 v23, v34, s3, v23
    v_exp_f32 v4, v4
    v_mul_f32 v72, v64, v72
    v_exp_f32 v5, v5
    v_mul_f32 v73, v65, v73
    s_waitcnt lgkmcnt(10)
    v_mfma_f32_32x32x16_bf16 v[80:95], v[112:115], v[208:211], v[80:95]
    ds_read_b64_tr_b16 v[104:105], v17 offset:20480
    ds_read_b64_tr_b16 v[106:107], v17 offset:20992
    s_lshr_b32 s3, s51, 1
    s_lshl_b32 s3, s3, 12
    s_add_u32 s3, s3, 262144
    s_mul_i32 s39, s101, 7
    s_add_u32 s40, s39, 6
    s_lshr_b32 s39, s39, 2
    s_lshr_b32 s40, s40, 2
    s_lshl_b32 s39, s39, 8
    s_lshl_b32 s40, s40, 8
    s_add_u32 s39, s39, s3
    s_add_u32 s40, s40, s3
    v_exp_f32 v6, v6
    v_mul_f32 v74, v66, v74
    v_exp_f32 v7, v7
    v_mul_f32 v75, v67, v75
    s_waitcnt lgkmcnt(10)
    v_mfma_f32_32x32x16_bf16 v[80:95], v[116:119], v[212:215], v[80:95]
    ds_read_b64_tr_b16 v[108:109], v17 offset:22528
    ds_read_b64_tr_b16 v[110:111], v17 offset:23040
    s_lshl_b32 s37, s51, 8
    s_lshr_b32 s38, s50, 3
    s_lshl_b32 s38, s38, 8
    s_lshl3_add_u32 s44, s52, s101
    s_lshr_b32 s44, s44, 1
    s_lshl_b32 s44, s44, 8
    s_lshl2_add_u32 s36, s48, s90
    s_lshr_b32 s36, s36, 1
    s_lshl_b32 s36, s36, 8
    v_fma_f32 v4, v4, v30, v30
    v_fma_f32 v5, v5, v30, v30
    v_fma_f32 v6, v6, v30, v30
    v_fma_f32 v7, v7, v30, v30
    v_rcp_f32 v4, v4
    s_waitcnt lgkmcnt(10)
    v_mfma_f32_32x32x16_bf16 v[80:95], v[120:123], v[216:219], v[80:95]
    ds_read_b64_tr_b16 v[112:113], v15 offset:16384
    ds_read_b64_tr_b16 v[114:115], v15 offset:16896
    s_add_u32 s35, s65, 118784
    buffer_load_dwordx4 v[200:203], v2, s[56:59], s35 offen offset:0 sc1
    s_load_dword s28, s[46:47], s39 offset:0
    s_load_dword s29, s[46:47], s39 offset:256
    s_load_dword s30, s[46:47], s40 offset:0
    s_load_dword s31, s[46:47], s36 offset:393216
    s_load_dword s32, s[46:47], s37 offset:393216
    s_load_dword s33, s[46:47], s38 offset:393216
    s_load_dword s34, s[46:47], s44 offset:393216
    v_rcp_f32 v5, v5
    v_rcp_f32 v6, v6
    v_rcp_f32 v7, v7
    s_waitcnt lgkmcnt(10)
    v_mfma_f32_32x32x16_bf16 v[80:95], v[124:127], v[220:223], v[80:95]
    ds_read_b64_tr_b16 v[116:117], v15 offset:18432
    ds_read_b64_tr_b16 v[118:119], v15 offset:18944
    s_add_u32 s35, s65, 118784
    buffer_load_dwordx4 v[204:207], v2, s[56:59], s35 offen offset:1024 sc1
    v_mul_f32 v72, v72, v4
    v_mul_f32 v73, v73, v5
    v_mul_f32 v74, v74, v6
    v_mul_f32 v75, v75, v7
    v_cvt_pk_bf16_f32 v64, v72, v73
    v_cvt_pk_bf16_f32 v65, v74, v75
    s_waitcnt lgkmcnt(10)
    v_mfma_f32_32x32x16_bf16 v[80:95], v[96:99], v[224:227], v[80:95]
    ds_read_b64_tr_b16 v[120:121], v15 offset:20480
    ds_read_b64_tr_b16 v[122:123], v15 offset:20992
    v_min_u32 v64, -2, v64
    v_min_u32 v65, -2, v65
    v_mul_f32 v4, v68, v68
    v_mul_f32 v5, v69, v69
    v_mul_f32 v6, v70, v70
    s_waitcnt lgkmcnt(10)
    v_mfma_f32_32x32x16_bf16 v[80:95], v[100:103], v[228:231], v[80:95]
    ds_read_b64_tr_b16 v[124:125], v15 offset:22528
    ds_read_b64_tr_b16 v[126:127], v15 offset:23040
    v_mul_f32 v7, v71, v71
    v_fma_f32 v4, v4, v29, v28
    v_fma_f32 v5, v5, v29, v28
    v_fma_f32 v6, v6, v29, v28
    v_fma_f32 v7, v7, v29, v28
    v_mul_f32 v4, v4, v68
    s_waitcnt lgkmcnt(10)
    v_mfma_f32_32x32x16_bf16 v[80:95], v[104:107], v[232:235], v[80:95]
    s_add_u32 s35, s65, 118784
    buffer_load_dwordx4 v[208:211], v2, s[56:59], s35 offen offset:2048 sc1
    v_mul_f32 v5, v5, v69
    v_mul_f32 v6, v6, v70
    v_mul_f32 v7, v7, v71
    v_exp_f32 v4, v4
    v_mul_f32 v76, v68, v76
    s_waitcnt lgkmcnt(8)
    v_mfma_f32_32x32x16_bf16 v[80:95], v[108:111], v[236:239], v[80:95]
    s_add_u32 s35, s65, 118784
    buffer_load_dwordx4 v[212:215], v2, s[56:59], s35 offen offset:3072 sc1
    v_exp_f32 v5, v5
    v_mul_f32 v77, v69, v77
    v_exp_f32 v6, v6
    v_mul_f32 v78, v70, v78
    ds_read_b64_tr_b16 v[96:97], v18 offset:1080
    ds_read_b64_tr_b16 v[98:99], v18 offset:1072
    ds_read_b128 v[100:103], v1 offset:1008
    ds_read_b128 v[104:107], v1 offset:1520
    ds_read_b64_tr_b16 v[108:109], v18 offset:568
    ds_read_b64_tr_b16 v[110:111], v18 offset:560
    s_waitcnt lgkmcnt(12)
    v_mfma_f32_32x32x16_bf16 v[80:95], v[112:115], v[240:243], v[80:95]
    ds_read_b128 v[112:115], v1 offset:2032
    v_exp_f32 v7, v7
    v_mul_f32 v79, v71, v79
    v_fma_f32 v4, v4, v30, v30
    v_fma_f32 v5, v5, v30, v30
    v_fma_f32 v6, v6, v30, v30
    s_waitcnt lgkmcnt(11)
    v_mfma_f32_32x32x16_bf16 v[80:95], v[116:119], v[244:247], v[80:95]
    ds_read_b64_tr_b16 v[116:117], v18 offset:56
    ds_read_b64_tr_b16 v[118:119], v18 offset:48
    v_fma_f32 v7, v7, v30, v30
    v_rcp_f32 v4, v4
    v_rcp_f32 v5, v5
    v_rcp_f32 v6, v6
    s_waitcnt lgkmcnt(11)
    v_mfma_f32_32x32x16_bf16 v[80:95], v[120:123], v[248:251], v[80:95]
    ds_read_b128 v[120:123], v1 offset:2544
    s_add_u32 s35, s65, 122880
    buffer_load_dwordx4 v[216:219], v2, s[56:59], s35 offen offset:0 sc1
    v_rcp_f32 v7, v7
    v_mul_f32 v76, v76, v4
    v_mul_f32 v77, v77, v5
    v_mul_f32 v78, v78, v6
    s_waitcnt lgkmcnt(10)
    v_mfma_f32_32x32x16_bf16 v[80:95], v[124:127], v[252:255], v[80:95]
    ds_read_b64_tr_b16 v[124:125], v18 offset:1016
    ds_read_b64_tr_b16 v[126:127], v18 offset:1008
    s_add_u32 s35, s65, 122880
    buffer_load_dwordx4 v[220:223], v2, s[56:59], s35 offen offset:1024 sc1
    v_mul_f32 v79, v79, v7
    v_cvt_pk_bf16_f32 v66, v76, v77
    v_cvt_pk_bf16_f32 v67, v78, v79
    v_min_u32 v66, -2, v66
    v_min_u32 v67, -2, v67
Ljoin:
    s_waitcnt lgkmcnt(9)
    v_mfma_f32_16x16x32_bf16 v[14:17], v[96:99], v[100:103], 0
    ds_read_b128 v[100:103], v1 offset:1072
    s_add_u32 s35, s65, 126976
    buffer_load_dwordx4 v[252:255], v2, s[56:59], s35 offen offset:0 sc1
    v_mul_f32 v4, v80, v80
    v_mul_f32 v5, v81, v81
    v_mul_f32 v6, v82, v82
    v_mul_f32 v7, v83, v83
    v_fma_f32 v4, v4, v29, v28
    v_fma_f32 v5, v5, v29, v28
    v_fma_f32 v6, v6, v29, v28
    v_fma_f32 v7, v7, v29, v28
    v_mul_f32 v4, v4, v80
    s_waitcnt lgkmcnt(9)
    v_mfma_f32_16x16x32_bf16 v[60:63], v[96:99], v[104:107], 0
    ds_read_b128 v[96:99], v1 offset:1584
    v_mul_f32 v5, v5, v81
    v_mul_f32 v6, v6, v82
    v_mul_f32 v7, v7, v83
    v_exp_f32 v4, v4
    v_mul_f32 v88, v80, v88
    v_exp_f32 v5, v5
    v_mul_f32 v89, v81, v89
    s_waitcnt lgkmcnt(8)
    v_mfma_f32_16x16x32_bf16 v[14:17], v[108:111], v[104:107], v[14:17]
    ds_read_b64_tr_b16 v[104:105], v18 offset:504
    ds_read_b64_tr_b16 v[106:107], v18 offset:496
    v_exp_f32 v6, v6
    v_mul_f32 v90, v82, v90
    v_exp_f32 v7, v7
    v_mul_f32 v91, v83, v91
    v_fma_f32 v4, v4, v30, v30
    v_fma_f32 v5, v5, v30, v30
    v_fma_f32 v6, v6, v30, v30
    s_waitcnt lgkmcnt(9)
    v_mfma_f32_16x16x32_bf16 v[60:63], v[108:111], v[112:115], v[60:63]
    ds_read_b128 v[108:111], v1 offset:2096
    s_waitcnt lgkmcnt(0)
    s_xor_b32 s28, s28, s100
    s_xor_b32 s29, s29, s100
    s_xor_b32 s30, s30, s100
    s_xor_b32 s31, s31, s100
    s_xor_b32 s32, s32, s100
    s_xor_b32 s33, s33, s100
    s_xor_b32 s34, s34, s100
    s_or_b32 s28, s28, s29
    s_or_b32 s28, s28, s30
    s_or_b32 s28, s28, s31
    s_or_b32 s28, s28, s32
    s_or_b32 s28, s28, s33
    s_or_b32 s28, s28, s34
    s_cbranch_scc1 Lsl_48
Lok_46:
    v_fma_f32 v7, v7, v30, v30
    v_rcp_f32 v4, v4
    v_rcp_f32 v5, v5
    v_rcp_f32 v6, v6
    v_rcp_f32 v7, v7
    s_add_u32 s3, s53, 114688
    buffer_load_dwordx4 v[32:35], v2, s[56:59], s3 offen offset:0 sc1
    v_mfma_f32_16x16x32_bf16 v[14:17], v[116:119], v[112:115], v[14:17]
    ds_read_b64_tr_b16 v[112:113], v18 offset:952
    ds_read_b64_tr_b16 v[114:115], v18 offset:944
    v_mul_f32 v88, v88, v4
    v_mul_f32 v89, v89, v5
    v_mul_f32 v90, v90, v6
    v_mul_f32 v91, v91, v7
    v_cvt_pk_bf16_f32 v80, v88, v89
    v_cvt_pk_bf16_f32 v81, v90, v91
    v_min_u32 v80, -2, v80
    v_min_u32 v81, -2, v81
    s_cmp_lg_u32 s95, 0
    s_cbranch_scc1 Lo_49
    buffer_store_dwordx4 v[64:67], v2, s[56:59], s91 offen offset:0 sc1
Lo_49:
    v_mfma_f32_16x16x32_bf16 v[60:63], v[116:119], v[120:123], v[60:63]
    ds_read_b128 v[116:119], v1 offset:1136
    ds_read_b128 v[120:123], v1 offset:1648
    v_mul_f32 v4, v84, v84
    v_mul_f32 v5, v85, v85
    v_mul_f32 v6, v86, v86
    v_mul_f32 v7, v87, v87
    v_fma_f32 v4, v4, v29, v28
    v_fma_f32 v5, v5, v29, v28
    v_fma_f32 v6, v6, v29, v28
    v_fma_f32 v7, v7, v29, v28
    v_mul_f32 v4, v4, v84
    s_add_u32 s3, s53, 114688
    buffer_load_dwordx4 v[36:39], v2, s[56:59], s3 offen offset:1024 sc1
    v_mfma_f32_16x16x32_bf16 v[14:17], v[124:127], v[100:103], v[14:17]
    ds_read_b64_tr_b16 v[100:101], v18 offset:440
    ds_read_b64_tr_b16 v[102:103], v18 offset:432
    v_mul_f32 v5, v5, v85
    v_mul_f32 v6, v6, v86
    v_mul_f32 v7, v7, v87
    v_exp_f32 v4, v4
    v_mul_f32 v92, v84, v92
    v_exp_f32 v5, v5
    v_mul_f32 v93, v85, v93
    v_mfma_f32_16x16x32_bf16 v[60:63], v[124:127], v[96:99], v[60:63]
    ds_read_b128 v[124:127], v1 offset:2160
    v_exp_f32 v6, v6
    v_mul_f32 v94, v86, v94
    v_exp_f32 v7, v7
    v_mul_f32 v95, v87, v95
    v_fma_f32 v4, v4, v30, v30
    v_fma_f32 v5, v5, v30, v30
    v_fma_f32 v6, v6, v30, v30
    s_add_u32 s3, s53, 114688
    buffer_load_dwordx4 v[40:43], v2, s[56:59], s3 offen offset:2048 sc1
    v_mfma_f32_16x16x32_bf16 v[14:17], v[104:107], v[96:99], v[14:17]
    ds_read_b64_tr_b16 v[96:97], v18 offset:888
    ds_read_b64_tr_b16 v[98:99], v18 offset:880
    v_fma_f32 v7, v7, v30, v30
    v_rcp_f32 v4, v4
    v_rcp_f32 v5, v5
    v_rcp_f32 v6, v6
    v_rcp_f32 v7, v7
    v_mfma_f32_16x16x32_bf16 v[60:63], v[104:107], v[108:111], v[60:63]
    ds_read_b128 v[104:107], v1 offset:1200
    ds_read_b128 v[108:111], v1 offset:1712
    v_mul_f32 v92, v92, v4
    v_mul_f32 v93, v93, v5
    v_mul_f32 v94, v94, v6
    v_mul_f32 v95, v95, v7
    v_cvt_pk_bf16_f32 v82, v92, v93
    v_cvt_pk_bf16_f32 v83, v94, v95
    v_min_u32 v82, -2, v82
    v_min_u32 v83, -2, v83
    s_add_u32 s3, s53, 114688
    buffer_load_dwordx4 v[44:47], v2, s[56:59], s3 offen offset:3072 sc1
    s_waitcnt lgkmcnt(8)
    v_mfma_f32_16x16x32_bf16 v[14:17], v[112:115], v[116:119], v[14:17]
    ds_read_b64_tr_b16 v[116:117], v18 offset:376
    ds_read_b64_tr_b16 v[118:119], v18 offset:368
    s_cmp_lg_u32 s95, 0
    s_cbranch_scc1 Lo_50
    buffer_store_dwordx4 v[80:83], v2, s[56:59], s91 offen offset:1024 sc1
Lo_50:
    s_setprio 2
    s_waitcnt lgkmcnt(9)
    v_mfma_f32_16x16x32_bf16 v[60:63], v[112:115], v[120:123], v[60:63]
    ds_read_b128 v[112:115], v1 offset:2224
    s_waitcnt lgkmcnt(8)
    v_mfma_f32_16x16x32_bf16 v[14:17], v[100:103], v[120:123], v[14:17]
    ds_read_b64_tr_b16 v[120:121], v18 offset:824
    ds_read_b64_tr_b16 v[122:123], v18 offset:816
    s_add_u32 s3, s53, 118784
    buffer_load_dwordx4 v[48:51], v2, s[56:59], s3 offen offset:0 sc1
    s_waitcnt lgkmcnt(9)
    v_mfma_f32_16x16x32_bf16 v[60:63], v[100:103], v[124:127], v[60:63]
    ds_read_b128 v[100:103], v1 offset:1264
    ds_read_b128 v[124:127], v1 offset:1776
    s_waitcnt lgkmcnt(8)
    v_mfma_f32_16x16x32_bf16 v[14:17], v[96:99], v[104:107], v[14:17]
    ds_read_b64_tr_b16 v[104:105], v18 offset:312
    ds_read_b64_tr_b16 v[106:107], v18 offset:304
    s_add_u32 s3, s53, 118784
    buffer_load_dwordx4 v[52:55], v2, s[56:59], s3 offen offset:1024 sc1
    s_waitcnt lgkmcnt(9)
    v_mfma_f32_16x16x32_bf16 v[60:63], v[96:99], v[108:111], v[60:63]
    ds_read_b128 v[96:99], v1 offset:2288
    s_waitcnt lgkmcnt(8)
    v_mfma_f32_16x16x32_bf16 v[14:17], v[116:119], v[108:111], v[14:17]
    ds_read_b64_tr_b16 v[108:109], v18 offset:760
    ds_read_b64_tr_b16 v[110:111], v18 offset:752
    s_add_u32 s3, s53, 118784
    buffer_load_dwordx4 v[56:59], v2, s[56:59], s3 offen offset:2048 sc1
    s_waitcnt lgkmcnt(9)
    v_mfma_f32_16x16x32_bf16 v[60:63], v[116:119], v[112:115], v[60:63]
    ds_read_b128 v[116:119], v1 offset:1328
    ds_read_b128 v[112:115], v1 offset:1840
    s_waitcnt lgkmcnt(8)
    v_mfma_f32_16x16x32_bf16 v[14:17], v[120:123], v[100:103], v[14:17]
    ds_read_b64_tr_b16 v[100:101], v18 offset:248
    ds_read_b64_tr_b16 v[102:103], v18 offset:240
    s_waitcnt lgkmcnt(9)
    v_mfma_f32_16x16x32_bf16 v[60:63], v[120:123], v[124:127], v[60:63]
    ds_read_b128 v[120:123], v1 offset:2352
    buffer_load_dwordx4 v[224:227], v2, s[56:59], s53 offen offset:0 sc1
    s_waitcnt lgkmcnt(8)
    v_mfma_f32_16x16x32_bf16 v[14:17], v[104:107], v[124:127], v[14:17]
    ds_read_b64_tr_b16 v[124:125], v18 offset:696
    ds_read_b64_tr_b16 v[126:127], v18 offset:688
    s_waitcnt lgkmcnt(9)
    v_mfma_f32_16x16x32_bf16 v[60:63], v[104:107], v[96:99], v[60:63]
    ds_read_b128 v[104:107], v1 offset:1392
    ds_read_b128 v[96:99], v1 offset:1904
    buffer_load_dwordx4 v[228:231], v2, s[56:59], s53 offen offset:1024 sc1
    s_waitcnt lgkmcnt(8)
    v_mfma_f32_16x16x32_bf16 v[14:17], v[108:111], v[116:119], v[14:17]
    ds_read_b64_tr_b16 v[116:117], v18 offset:184
    ds_read_b64_tr_b16 v[118:119], v18 offset:176
    s_waitcnt lgkmcnt(9)
    v_mfma_f32_16x16x32_bf16 v[60:63], v[108:111], v[112:115], v[60:63]
    ds_read_b128 v[108:111], v1 offset:2416
    buffer_load_dwordx4 v[232:235], v2, s[56:59], s53 offen offset:2048 sc1
    s_waitcnt lgkmcnt(8)
    v_mfma_f32_16x16x32_bf16 v[14:17], v[100:103], v[112:115], v[14:17]
    ds_read_b64_tr_b16 v[112:113], v18 offset:632
    ds_read_b64_tr_b16 v[114:115], v18 offset:624
    s_waitcnt lgkmcnt(9)
    v_mfma_f32_16x16x32_bf16 v[60:63], v[100:103], v[120:123], v[60:63]
    ds_read_b128 v[100:103], v1 offset:1456
    ds_read_b128 v[120:123], v1 offset:1968
    s_waitcnt lgkmcnt(8)
    v_mfma_f32_16x16x32_bf16 v[14:17], v[124:127], v[104:107], v[14:17]
    ds_read_b64_tr_b16 v[104:105], v18 offset:120
    ds_read_b64_tr_b16 v[106:107], v18 offset:112
    buffer_load_dwordx4 v[236:239], v2, s[56:59], s53 offen offset:3072 sc1
    s_waitcnt lgkmcnt(9)
    v_mfma_f32_16x16x32_bf16 v[60:63], v[124:127], v[96:99], v[60:63]
    ds_read_b128 v[124:127], v1 offset:2480
    s_waitcnt lgkmcnt(8)
    v_mfma_f32_16x16x32_bf16 v[14:17], v[116:119], v[96:99], v[14:17]
    ds_read_b64_tr_b16 v[96:97], v22 offset:1792
    ds_read_b64_tr_b16 v[98:99], v22 offset:1920
    s_add_u32 s3, s53, 4096
    buffer_load_dwordx4 v[240:243], v2, s[56:59], s3 offen offset:0 sc1
    s_waitcnt lgkmcnt(9)
    v_mfma_f32_16x16x32_bf16 v[60:63], v[116:119], v[108:111], v[60:63]
    ds_read_b64_tr_b16 v[116:117], v19 offset:1152
    ds_read_b64_tr_b16 v[118:119], v19 offset:1144
    ds_read_b64_tr_b16 v[108:109], v22 offset:1280
    ds_read_b64_tr_b16 v[110:111], v22 offset:1408
    s_waitcnt lgkmcnt(10)
    v_mfma_f32_16x16x32_bf16 v[14:17], v[112:115], v[100:103], v[14:17]
    ds_read_b64_tr_b16 v[100:101], v22 offset:1536
    ds_read_b64_tr_b16 v[102:103], v22 offset:1664
    s_add_u32 s3, s53, 4096
    buffer_load_dwordx4 v[244:247], v2, s[56:59], s3 offen offset:1024 sc1
    s_waitcnt lgkmcnt(11)
    v_mfma_f32_16x16x32_bf16 v[60:63], v[112:115], v[120:123], v[60:63]
    ds_read_b64_tr_b16 v[112:113], v19 offset:1168
    ds_read_b64_tr_b16 v[114:115], v19 offset:1160
    s_waitcnt lgkmcnt(11)
    v_mfma_f32_16x16x32_bf16 v[14:17], v[104:107], v[120:123], v[14:17]
    ds_read_b64_tr_b16 v[120:121], v22 offset:1024
    ds_read_b64_tr_b16 v[122:123], v22 offset:1152
    s_waitcnt lgkmcnt(12)
    v_mfma_f32_16x16x32_bf16 v[60:63], v[104:107], v[124:127], v[60:63]
    ds_read_b64_tr_b16 v[104:105], v19 offset:1184
    ds_read_b64_tr_b16 v[106:107], v19 offset:1176
    ds_read_b64_tr_b16 v[124:125], v19 offset:1200
    ds_read_b64_tr_b16 v[126:127], v19 offset:1192
    s_add_u32 s3, s53, 4096
    buffer_load_dwordx4 v[248:251], v2, s[56:59], s3 offen offset:2048 sc1
    s_cmp_eq_u32 s69, 0
    s_cbranch_scc1 Lcend
    s_waitcnt lgkmcnt(12)
    v_mfma_f32_16x16x32_bf16 v[60:63], v[96:99], v[116:119], v[60:63]
    ds_read_b64_tr_b16 v[96:97], v18 offset:1136
    ds_read_b64_tr_b16 v[98:99], v18 offset:1128
    s_waitcnt lgkmcnt(12)
    v_mfma_f32_16x16x32_bf16 v[14:17], v[108:111], v[116:119], v[14:17]
    ds_read_b128 v[116:119], v1 offset:512
    s_waitcnt lgkmcnt(9)
    v_mfma_f32_16x16x32_bf16 v[60:63], v[100:103], v[112:115], v[60:63]
    ds_read_b128 v[100:103], v1 offset:0
    s_waitcnt lgkmcnt(8)
    v_mfma_f32_16x16x32_bf16 v[14:17], v[120:123], v[112:115], v[14:17]
    ds_read_b64_tr_b16 v[112:113], v22 offset:768
    ds_read_b64_tr_b16 v[114:115], v22 offset:896
    s_waitcnt lgkmcnt(8)
    v_mfma_f32_16x16x32_bf16 v[60:63], v[108:111], v[104:107], v[60:63]
    ds_read_b64_tr_b16 v[108:109], v19 offset:1216
    ds_read_b64_tr_b16 v[110:111], v19 offset:1208
    s_waitcnt lgkmcnt(8)
    v_mfma_f32_16x16x32_bf16 v[60:63], v[120:123], v[124:127], v[60:63]
    ds_read_b64_tr_b16 v[120:121], v22 offset:512
    ds_read_b64_tr_b16 v[122:123], v22 offset:640
    s_waitcnt lgkmcnt(7)
    v_mfma_f32_16x16x32_bf16 v[60:63], v[96:99], v[116:119], v[60:63]
    ds_read_b64_tr_b16 v[116:117], v19 offset:1232
    ds_read_b64_tr_b16 v[118:119], v19 offset:1224
    s_cmp_eq_u32 s69, 1
    s_cbranch_scc1 Lcend
    s_waitcnt lgkmcnt(8)
    v_mfma_f32_16x16x32_bf16 v[14:17], v[96:99], v[100:103], v[14:17]
    ds_read_b64_tr_b16 v[96:97], v22 offset:256
    ds_read_b64_tr_b16 v[98:99], v22 offset:384
    ds_read_b64_tr_b16 v[100:101], v22 offset:0
    ds_read_b64_tr_b16 v[102:103], v22 offset:128
    s_waitcnt lgkmcnt(10)
    v_mfma_f32_16x16x32_bf16 v[14:17], v[112:115], v[104:107], v[14:17]
    ds_read_b64_tr_b16 v[104:105], v23 offset:1536
    ds_read_b64_tr_b16 v[106:107], v23 offset:1792
    s_waitcnt lgkmcnt(10)
    v_mfma_f32_16x16x32_bf16 v[60:63], v[112:115], v[108:111], v[60:63]
    ds_read_b64_tr_b16 v[112:113], v21 offset:1552
    ds_read_b64_tr_b16 v[114:115], v21 offset:1536
    s_waitcnt lgkmcnt(10)
    v_mfma_f32_16x16x32_bf16 v[14:17], v[120:123], v[124:127], v[14:17]
    ds_read_b64_tr_b16 v[124:125], v23 offset:1024
    ds_read_b64_tr_b16 v[126:127], v23 offset:1280
    s_waitcnt lgkmcnt(10)
    v_mfma_f32_16x16x32_bf16 v[60:63], v[120:123], v[116:119], v[60:63]
    ds_read_b64_tr_b16 v[120:121], v21 offset:1584
    ds_read_b64_tr_b16 v[122:123], v21 offset:1568
    s_waitcnt lgkmcnt(10)
    v_mfma_f32_16x16x32_bf16 v[14:17], v[96:99], v[108:111], v[14:17]
    ds_read_b64_tr_b16 v[96:97], v23 offset:512
    ds_read_b64_tr_b16 v[98:99], v23 offset:768
    ds_read_b64_tr_b16 v[108:109], v21 offset:1616
    ds_read_b64_tr_b16 v[110:111], v21 offset:1600
    s_waitcnt lgkmcnt(12)
    v_mfma_f32_16x16x32_bf16 v[14:17], v[100:103], v[116:119], v[14:17]
    ds_read_b64_tr_b16 v[100:101], v23 offset:0
    ds_read_b64_tr_b16 v[102:103], v23 offset:256
    ds_read_b64_tr_b16 v[116:117], v21 offset:1648
    ds_read_b64_tr_b16 v[118:119], v21 offset:1632
    s_waitcnt lgkmcnt(12)
    v_mfma_f32_16x16x32_bf16 v[60:63], v[104:107], v[112:115], v[60:63]
    s_waitcnt lgkmcnt(10)
    v_mfma_f32_16x16x32_bf16 v[14:17], v[124:127], v[112:115], v[14:17]
    s_waitcnt lgkmcnt(8)
    v_mfma_f32_16x16x32_bf16 v[60:63], v[124:127], v[120:123], v[60:63]
    s_cmp_eq_u32 s69, 2
    s_cbranch_scc1 Lcend
    s_waitcnt lgkmcnt(6)
    v_mfma_f32_16x16x32_bf16 v[14:17], v[96:99], v[120:123], v[14:17]
    s_waitcnt lgkmcnt(4)
    v_mfma_f32_16x16x32_bf16 v[60:63], v[96:99], v[108:111], v[60:63]
    s_waitcnt lgkmcnt(2)
    v_mfma_f32_16x16x32_bf16 v[14:17], v[100:103], v[108:111], v[14:17]
    s_waitcnt lgkmcnt(0)
    v_mfma_f32_16x16x32_bf16 v[60:63], v[100:103], v[116:119], v[60:63]
Lcend:
    s_setprio 1
    s_waitcnt vmcnt(13) lgkmcnt(2)
    v_mfma_f32_32x32x16_bf16 v[96:111], v[32:35], v[128:131], 0
    s_nop 2
    v_cvt_pk_bf16_f32 v14, v14, v15
    v_cvt_pk_bf16_f32 v15, v16, v17
    v_cvt_pk_bf16_f32 v16, v60, v61
    v_cvt_pk_bf16_f32 v17, v62, v63
    s_mov_b32 s3, 0xfffefffe
    v_pk_min_u16 v14, v14, s3
    v_pk_min_u16 v15, v15, s3
    v_pk_min_u16 v16, v16, s3
    v_pk_min_u16 v17, v17, s3
    s_lshl1_add_u32 s98, s50, s68
    s_lshl2_add_u32 s98, s98, s69
    s_lshl_b32 s98, s98, 10
    s_add_u32 s98, s98, 12582912
    v_permlane16_swap_b32 v14, v16
    v_permlane16_swap_b32 v15, v17
    buffer_store_dwordx4 v[14:17], v2, s[56:59], s98 offen sc1
    s_waitcnt lgkmcnt(0)
    v_mfma_f32_32x32x16_bf16 v[112:127], v[32:35], v[132:135], 0
    v_mov_b32 v31, 146272
    v_mov_b32 v12, 1
    s_mov_b64 exec, 1
    ds_add_u32 v31, v12 offset:8
    s_mov_b64 exec, -1
    s_waitcnt vmcnt(13)
    v_mfma_f32_32x32x16_bf16 v[96:111], v[36:39], v[136:139], v[96:111]
    s_add_u32 s35, s65, 126976
    buffer_load_dwordx4 v[60:63], v2, s[56:59], s35 offen offset:1024 sc1
    v_mfma_f32_32x32x16_bf16 v[112:127], v[36:39], v[140:143], v[112:127]
    v_and_b32 v5, 15, v0
    v_lshrrev_b32 v6, 5, v0
    s_waitcnt vmcnt(13)
    v_mfma_f32_32x32x16_bf16 v[96:111], v[40:43], v[144:147], v[96:111]
    v_and_b32 v7, 16, v0
    v_lshlrev_b32 v20, 3, v5
    v_mfma_f32_32x32x16_bf16 v[112:127], v[40:43], v[148:151], v[112:127]
    v_lshl_or_b32 v20, v6, 10, v20
    v_lshl_or_b32 v20, v7, 8, v20
    s_waitcnt vmcnt(12)
    v_mfma_f32_32x32x16_bf16 v[96:111], v[44:47], v[152:155], v[96:111]
    s_lshl_b32 s66, s51, 3
    s_lshr_b32 s3, s101, 1
    s_add_u32 s66, s66, s3
    s_lshl_b32 s66, s66, 2
    s_and_b32 s3, s101, 1
    s_add_u32 s66, s66, s3
    s_lshl_b32 s66, s66, 4
    s_add_u32 s66, s66, s52
    s_lshl_b32 s66, s66, 7
    s_add_u32 s64, s66, 32768
    v_mfma_f32_32x32x16_bf16 v[112:127], v[44:47], v[156:159], v[112:127]
    s_waitcnt vmcnt(11)
    v_mfma_f32_32x32x16_bf16 v[96:111], v[48:51], v[160:163], v[96:111]
    v_and_b32 v28, 0x70, v2
    v_lshl_or_b32 v28, v7, 3, v28
    s_add_u32 s3, s53, 172032
    buffer_load_dwordx4 v[32:35], v2, s[56:59], s3 offen offset:0 sc1
    s_add_u32 s3, s53, 172032
    buffer_load_dwordx4 v[36:39], v2, s[56:59], s3 offen offset:1024 sc1
    v_mfma_f32_32x32x16_bf16 v[112:127], v[48:51], v[164:167], v[112:127]
    v_lshl_or_b32 v28, v6, 8, v28
    v_and_b32 v4, 8, v0
    s_add_u32 s3, s53, 172032
    buffer_load_dwordx4 v[40:43], v2, s[56:59], s3 offen offset:2048 sc1
    s_add_u32 s3, s53, 172032
    buffer_load_dwordx4 v[44:47], v2, s[56:59], s3 offen offset:3072 sc1
    s_waitcnt vmcnt(14)
    v_mfma_f32_32x32x16_bf16 v[96:111], v[52:55], v[168:171], v[96:111]
    v_lshl_or_b32 v28, v4, 9, v28
    s_add_u32 s3, s53, 176128
    buffer_load_dwordx4 v[48:51], v2, s[56:59], s3 offen offset:0 sc1
    v_mfma_f32_32x32x16_bf16 v[112:127], v[52:55], v[172:175], v[112:127]
    s_lshl_b32 s3, s101, 9
    v_add_u32 v28, s3, v28
    v_lshrrev_b32 v29, 3, v0
    s_add_u32 s3, s53, 176128
    buffer_load_dwordx4 v[52:55], v2, s[56:59], s3 offen offset:1024 sc1
    s_waitcnt vmcnt(15)
    v_mfma_f32_32x32x16_bf16 v[96:111], v[56:59], v[176:179], v[96:111]
    v_and_b32 v4, 0x30, v2
    v_mfma_f32_32x32x16_bf16 v[112:127], v[56:59], v[180:183], v[112:127]
    v_lshl_or_b32 v29, v29, 12, v4
    v_and_b32 v4, 4, v0
    s_add_u32 s3, s53, 176128
    buffer_load_dwordx4 v[56:59], v2, s[56:59], s3 offen offset:2048 sc1
    s_waitcnt vmcnt(15)
    v_mfma_f32_32x32x16_bf16 v[64:79], v[224:227], v[128:131], 0
    v_lshl_or_b32 v29, v4, 7, v29
    s_lshl_b32 s41, s52, 3
    s_add_u32 s41, s41, s101
    s_lshl_b32 s41, s41, 9
    s_add_u32 s41, s41, s51
    s_andn2_b32 s3, s51, 7
    s_add_u32 s41, s41, s3
    s_lshl_b32 s41, s41, 6
    s_add_u32 s41, s41, 12582912
    s_mul_i32 s45, s101, 1056
    s_add_u32 s45, s45, 155328
    v_mfma_f32_32x32x16_bf16 v[80:95], v[224:227], v[132:135], 0
    s_add_u32 s3, s53, 57344
    buffer_load_dwordx4 v[224:227], v2, s[56:59], s3 offen offset:0 sc1
    s_waitcnt vmcnt(15)
    v_mfma_f32_32x32x16_bf16 v[64:79], v[228:231], v[136:139], v[64:79]
    v_and_b32 v30, 48, v0
    v_mfma_f32_32x32x16_bf16 v[80:95], v[228:231], v[140:143], v[80:95]
    v_and_b32 v4, 1, v0
    v_lshl_or_b32 v30, v4, 3, v30
    s_add_u32 s3, s53, 57344
    buffer_load_dwordx4 v[228:231], v2, s[56:59], s3 offen offset:1024 sc1
    s_waitcnt vmcnt(15)
    v_mfma_f32_32x32x16_bf16 v[64:79], v[232:235], v[144:147], v[64:79]
    v_and_b32 v4, 14, v0
    v_lshl_or_b32 v30, v4, 5, v30
    v_mfma_f32_32x32x16_bf16 v[80:95], v[232:235], v[148:151], v[80:95]
    v_add_u32 v30, s45, v30
    s_add_u32 s3, s53, 57344
    buffer_load_dwordx4 v[232:235], v2, s[56:59], s3 offen offset:2048 sc1
    s_waitcnt vmcnt(15)
    v_mfma_f32_32x32x16_bf16 v[64:79], v[236:239], v[152:155], v[64:79]
    v_mfma_f32_32x32x16_bf16 v[80:95], v[236:239], v[156:159], v[80:95]
    s_add_u32 s3, s53, 57344
    buffer_load_dwordx4 v[236:239], v2, s[56:59], s3 offen offset:3072 sc1
    s_waitcnt vmcnt(15)
    v_mfma_f32_32x32x16_bf16 v[64:79], v[240:243], v[160:163], v[64:79]
    v_mfma_f32_32x32x16_bf16 v[80:95], v[240:243], v[164:167], v[80:95]
    s_add_u32 s3, s53, 61440
    buffer_load_dwordx4 v[240:243], v2, s[56:59], s3 offen offset:0 sc1
    s_waitcnt vmcnt(15)
    v_mfma_f32_32x32x16_bf16 v[64:79], v[244:247], v[168:171], v[64:79]
    s_waitcnt vmcnt(11)
    v_max_u32 v12, v32, v33
    v_max3_u32 v12, v12, v34, v35
    s_waitcnt vmcnt(10)
    v_max3_u32 v12, v12, v36, v37
    v_max3_u32 v12, v12, v38, v39
    v_mfma_f32_32x32x16_bf16 v[80:95], v[244:247], v[172:175], v[80:95]
    s_waitcnt vmcnt(9)
    v_max3_u32 v12, v12, v40, v41
    v_max3_u32 v12, v12, v42, v43
    s_waitcnt vmcnt(8)
    v_max3_u32 v12, v12, v44, v45
    s_add_u32 s3, s53, 61440
    buffer_load_dwordx4 v[244:247], v2, s[56:59], s3 offen offset:1024 sc1
    v_mfma_f32_32x32x16_bf16 v[64:79], v[248:251], v[176:179], v[64:79]
    v_max3_u32 v12, v12, v46, v47
    s_waitcnt vmcnt(8)
    v_max3_u32 v12, v12, v48, v49
    v_max3_u32 v12, v12, v50, v51
    s_waitcnt vmcnt(7)
    v_max3_u32 v12, v12, v52, v53
    v_mfma_f32_32x32x16_bf16 v[80:95], v[248:251], v[180:183], v[80:95]
    s_setprio 0
    v_max3_u32 v12, v12, v54, v55
    s_waitcnt vmcnt(6)
    v_max3_u32 v12, v12, v56, v57
    v_max3_u32 v12, v12, v58, v59
    v_cmp_eq_u32 vcc, -1, v12
    s_nop 1
    s_cmp_eq_u64 vcc, 0
    s_cbranch_scc0 Lsl_53
Lok_51:
    s_add_u32 s3, s53, 61440
    buffer_load_dwordx4 v[248:251], v2, s[56:59], s3 offen offset:2048 sc1
    v_mfma_f32_32x32x16_bf16 v[96:111], v[32:35], v[184:187], v[96:111]
    buffer_load_dwordx2 v[22:23], v20, s[4:7], s66 offen
    buffer_load_dwordx2 v[18:19], v20, s[4:7], s64 offen
    v_mfma_f32_32x32x16_bf16 v[96:111], v[36:39], v[192:195], v[96:111]
    v_mfma_f32_32x32x16_bf16 v[96:111], v[40:43], v[200:203], v[96:111]
    v_lshrrev_b32 v3, 6, v20
    v_and_b32 v3, 0x70, v3
    v_and_b32 v4, 8, v20
    v_or_b32 v3, v3, v4
    v_bfe_u32 v4, v0, 1, 3
    v_mul_u32_u24 v4, 1056, v4
    s_lshr_b32 s3, s66, 6
    s_and_b32 s3, s3, 0x1f0
    s_add_u32 s3, s3, 155328
    v_add3_u32 v3, v3, v4, s3
    v_add_u32 v21, s45, v2
    v_add_u32 v1, 0x10000, v28
    s_mov_b32 m0, s45
    s_nop 0
    buffer_load_dwordx4 v29, s[56:59], s41 offen sc1 lds
    v_mfma_f32_32x32x16_bf16 v[96:111], v[44:47], v[208:211], v[96:111]
    v_mfma_f32_32x32x16_bf16 v[96:111], v[48:51], v[216:219], v[96:111]
    ds_read_b32 v179, v31 offset:8
    v_mfma_f32_32x32x16_bf16 v[96:111], v[52:55], v[8:11], v[96:111]
    v_mfma_f32_32x32x16_bf16 v[96:111], v[56:59], v[252:255], v[96:111]
    v_mfma_f32_32x32x16_bf16 v[112:127], v[32:35], v[188:191], v[112:127]
    s_lshl_b32 m0, s101, 13
    s_waitcnt lgkmcnt(0)
    v_readfirstlane_b32 s3, v179
    s_nop 0
    s_cmp_eq_u32 s3, 8
    s_cbranch_scc0 Lsl_56
Lok_54:
    v_mfma_f32_32x32x16_bf16 v[112:127], v[36:39], v[196:199], v[112:127]
    s_nop 3
    ds_write_addtid_b32 v96 offset:0
    ds_write_addtid_b32 v97 offset:256
    ds_write_addtid_b32 v98 offset:512
    ds_write_addtid_b32 v99 offset:768
    v_mfma_f32_32x32x16_bf16 v[112:127], v[40:43], v[204:207], v[112:127]
    ds_write_addtid_b32 v100 offset:1024
    ds_write_addtid_b32 v101 offset:1280
    ds_write_addtid_b32 v102 offset:1536
    v_mfma_f32_32x32x16_bf16 v[112:127], v[44:47], v[212:215], v[112:127]
    s_waitcnt vmcnt(9)
    v_max_u32 v12, v224, v225
    v_max3_u32 v12, v12, v226, v227
    s_waitcnt vmcnt(8)
    v_max3_u32 v12, v12, v228, v229
    v_max3_u32 v12, v12, v230, v231
    ds_write_addtid_b32 v103 offset:1792
    ds_write_addtid_b32 v104 offset:2048
    ds_write_addtid_b32 v105 offset:2304
    v_mfma_f32_32x32x16_bf16 v[112:127], v[48:51], v[220:223], v[112:127]
    s_waitcnt vmcnt(7)
    v_max3_u32 v12, v12, v232, v233
    v_max3_u32 v12, v12, v234, v235
    s_waitcnt vmcnt(6)
    v_max3_u32 v12, v12, v236, v237
    ds_write_addtid_b32 v106 offset:2560
    ds_write_addtid_b32 v107 offset:2816
    ds_write_addtid_b32 v108 offset:3072
    v_mfma_f32_32x32x16_bf16 v[112:127], v[52:55], v[24:27], v[112:127]
    v_max3_u32 v12, v12, v238, v239
    s_waitcnt vmcnt(5)
    v_max3_u32 v12, v12, v240, v241
    v_max3_u32 v12, v12, v242, v243
    s_waitcnt vmcnt(4)
    v_max3_u32 v12, v12, v244, v245
    ds_write_addtid_b32 v109 offset:3328
    ds_write_addtid_b32 v110 offset:3584
    ds_write_addtid_b32 v111 offset:3840
    v_mfma_f32_32x32x16_bf16 v[112:127], v[56:59], v[60:63], v[112:127]
    v_max3_u32 v12, v12, v246, v247
    s_waitcnt vmcnt(3)
    v_max3_u32 v12, v12, v248, v249
    v_max3_u32 v12, v12, v250, v251
    v_cmp_eq_u32 vcc, -1, v12
    s_nop 1
    s_cmp_eq_u64 vcc, 0
    s_cbranch_scc0 Lsl_59
Lok_57:
    v_mfma_f32_32x32x16_bf16 v[64:79], v[224:227], v[184:187], v[64:79]
    s_waitcnt vmcnt(0)
    ds_read_b64_tr_b16 v[128:129], v30
    ds_read_b64_tr_b16 v[130:131], v30 offset:512
    ds_write_addtid_b32 v112 offset:4096
    ds_write_addtid_b32 v113 offset:4352
    ds_write_addtid_b32 v114 offset:4608
    ds_write_addtid_b32 v115 offset:4864
    v_mfma_f32_32x32x16_bf16 v[64:79], v[228:231], v[192:195], v[64:79]
    ds_write_addtid_b32 v116 offset:5120
    ds_write_addtid_b32 v117 offset:5376
    ds_write_addtid_b32 v118 offset:5632
    ds_write_addtid_b32 v119 offset:5888
    v_mfma_f32_32x32x16_bf16 v[64:79], v[232:235], v[200:203], v[64:79]
    ds_write_addtid_b32 v120 offset:6144
    ds_write_addtid_b32 v121 offset:6400
    ds_write_addtid_b32 v122 offset:6656
    ds_write_addtid_b32 v123 offset:6912
    v_mfma_f32_32x32x16_bf16 v[64:79], v[236:239], v[208:211], v[64:79]
    ds_write_addtid_b32 v124 offset:7168
    ds_write_addtid_b32 v125 offset:7424
    ds_write_addtid_b32 v126 offset:7680
    ds_write_addtid_b32 v127 offset:7936
    s_waitcnt lgkmcnt(15)
    v_pk_max_u16 v12, v128, v129
    v_pk_max_u16 v13, v130, v131
    v_pk_max_u16 v12, v12, v13
    v_lshlrev_b32 v13, 16, v12
    v_max_u32 v12, v12, v13
    v_or_b32 v12, 0xffff, v12
    v_cmp_eq_u32 vcc, -1, v12
    s_nop 1
    s_cmp_eq_u64 vcc, 0
    s_cbranch_scc0 Lsl_62
Lok_60:
    ds_write_b128 v21, v[128:131]
    v_mov_b32 v178, 1
    s_mov_b64 exec, 1
    ds_add_u32 v31, v178 offset:4
    s_mov_b64 exec, -1
    v_mfma_f32_32x32x16_bf16 v[64:79], v[240:243], v[216:219], v[64:79]
    v_mfma_f32_32x32x16_bf16 v[64:79], v[244:247], v[8:11], v[64:79]
    s_lshl_b32 s3, s101, 13
    s_add_u32 m0, s3, 7940
    v_mfma_f32_32x32x16_bf16 v[64:79], v[248:251], v[252:255], v[64:79]
    v_lshlrev_b32 v14, 16, v22
    v_and_b32 v15, 0xffff0000, v22
    v_lshlrev_b32 v16, 16, v23
    v_and_b32 v17, 0xffff0000, v23
    v_mfma_f32_32x32x16_bf16 v[80:95], v[224:227], v[188:191], v[80:95]
    v_lshlrev_b32 v4, 16, v18
    v_and_b32 v5, 0xffff0000, v18
    v_lshlrev_b32 v6, 16, v19
    v_and_b32 v7, 0xffff0000, v19
    s_mov_b32 s8, s42
    s_mov_b32 s9, s43
    s_mov_b32 s10, 0x200000
    s_mov_b32 s11, 0x00020000
    v_mfma_f32_32x32x16_bf16 v[80:95], v[228:231], v[196:199], v[80:95]
    ds_write_addtid_b32 v64 offset:57596
    ds_write_addtid_b32 v65 offset:57852
    ds_write_addtid_b32 v66 offset:58108
    ds_write_addtid_b32 v67 offset:58364
    v_mfma_f32_32x32x16_bf16 v[80:95], v[232:235], v[204:207], v[80:95]
    ds_write_addtid_b32 v68 offset:58620
    ds_write_addtid_b32 v69 offset:58876
    ds_write_addtid_b32 v70 offset:59132
    s_cmp_ge_u32 s101, 4
    s_cbranch_scc1 Ltl
    v_mfma_f32_32x32x16_bf16 v[80:95], v[236:239], v[212:215], v[80:95]
    ds_write_addtid_b32 v71 offset:59388
    ds_write_addtid_b32 v72 offset:59644
    ds_write_addtid_b32 v73 offset:59900
    v_mfma_f32_32x32x16_bf16 v[80:95], v[240:243], v[220:223], v[80:95]
    ds_write_addtid_b32 v74 offset:60156
    ds_write_addtid_b32 v75 offset:60412
    ds_write_addtid_b32 v76 offset:60668
    v_mfma_f32_32x32x16_bf16 v[80:95], v[244:247], v[24:27], v[80:95]
    ds_write_addtid_b32 v77 offset:60924
    ds_write_addtid_b32 v78 offset:61180
    ds_write_addtid_b32 v79 offset:61436
    v_mfma_f32_32x32x16_bf16 v[80:95], v[248:251], v[60:63], v[80:95]
    s_nop 11
    ds_write_addtid_b32 v80 offset:61692
    ds_write_addtid_b32 v81 offset:61948
    ds_write_addtid_b32 v82 offset:62204
    ds_write_addtid_b32 v83 offset:62460
    ds_write_addtid_b32 v84 offset:62716
    ds_write_addtid_b32 v85 offset:62972
    ds_write_addtid_b32 v86 offset:63228
    ds_write_addtid_b32 v87 offset:63484
    ds_write_addtid_b32 v88 offset:63740
    ds_write_addtid_b32 v89 offset:63996
    ds_write_addtid_b32 v90 offset:64252
    ds_write_addtid_b32 v91 offset:64508
    ds_write_addtid_b32 v92 offset:64764
    ds_write_addtid_b32 v93 offset:65020
    ds_write_addtid_b32 v94 offset:65276
    ds_write_addtid_b32 v95 offset:65532
    s_mov_b32 s28, 400000
Lsp_64:
    ds_read_b32 v179, v31 offset:4
    s_sub_u32 s28, s28, 1
    s_cbranch_scc1 Lok_63
    s_waitcnt lgkmcnt(0)
    v_readfirstlane_b32 s3, v179
    s_nop 0
    s_cmp_eq_u32 s3, 8
    s_cbranch_scc0 Lsp_64
Lok_63:
    ds_read_b64 v[192:193], v3 offset:512
    ds_read_b64 v[200:201], v3
    ds_read_b128 v[128:131], v28 offset:0
    ds_read_b128 v[132:135], v28 offset:8192
    ds_read_b128 v[136:139], v28 offset:16384
    ds_read_b128 v[140:143], v28 offset:24576
    ds_read_b128 v[144:147], v28 offset:32768
    ds_read_b128 v[148:151], v28 offset:40960
    ds_read_b128 v[152:155], v28 offset:49152
    ds_read_b128 v[156:159], v28 offset:57344
    s_waitcnt lgkmcnt(9)
    v_lshlrev_b32 v196, 16, v192
    v_and_b32 v197, 0xffff0000, v192
    v_lshlrev_b32 v198, 16, v193
    v_and_b32 v199, 0xffff0000, v193
    v_pk_add_f32 v[4:5], v[4:5], v[196:197]
    v_pk_add_f32 v[6:7], v[6:7], v[198:199]
    s_waitcnt lgkmcnt(8)
    v_lshlrev_b32 v196, 16, v200
    v_and_b32 v197, 0xffff0000, v200
    v_lshlrev_b32 v198, 16, v201
    v_and_b32 v199, 0xffff0000, v201
    v_pk_add_f32 v[14:15], v[14:15], v[196:197]
    v_pk_add_f32 v[16:17], v[16:17], v[198:199]
    s_waitcnt lgkmcnt(7)
    v_pk_add_f32 v[4:5], v[4:5], v[128:129]
    v_pk_add_f32 v[6:7], v[6:7], v[130:131]
    s_waitcnt lgkmcnt(5)
    v_pk_add_f32 v[132:133], v[132:133], v[136:137]
    v_pk_add_f32 v[134:135], v[134:135], v[138:139]
    s_waitcnt lgkmcnt(4)
    v_pk_add_f32 v[4:5], v[4:5], v[140:141]
    v_pk_add_f32 v[6:7], v[6:7], v[142:143]
    s_waitcnt lgkmcnt(3)
    v_pk_add_f32 v[132:133], v[132:133], v[144:145]
    v_pk_add_f32 v[134:135], v[134:135], v[146:147]
    s_waitcnt lgkmcnt(2)
    v_pk_add_f32 v[4:5], v[4:5], v[148:149]
    v_pk_add_f32 v[6:7], v[6:7], v[150:151]
    s_waitcnt lgkmcnt(1)
    v_pk_add_f32 v[132:133], v[132:133], v[152:153]
    v_pk_add_f32 v[134:135], v[134:135], v[154:155]
    s_waitcnt lgkmcnt(0)
    v_pk_add_f32 v[4:5], v[4:5], v[156:157]
    v_pk_add_f32 v[6:7], v[6:7], v[158:159]
    v_pk_add_f32 v[4:5], v[4:5], v[132:133]
    v_pk_add_f32 v[6:7], v[6:7], v[134:135]
    v_cvt_pk_bf16_f32 v4, v4, v5
    v_cvt_pk_bf16_f32 v5, v6, v7
    buffer_store_dwordx2 v[4:5], v20, s[8:11], s64 offen sc1
    s_barrier
    ds_read_b128 v[128:131], v1 offset:0
    ds_read_b128 v[132:135], v1 offset:8192
    ds_read_b128 v[136:139], v1 offset:16384
    ds_read_b128 v[140:143], v1 offset:24576
    ds_read_b128 v[144:147], v1 offset:32768
    ds_read_b128 v[148:151], v1 offset:40960
    ds_read_b128 v[152:155], v1 offset:49152
    ds_read_b128 v[156:159], v1 offset:57344
    s_waitcnt lgkmcnt(7)
    v_pk_add_f32 v[14:15], v[14:15], v[128:129]
    v_pk_add_f32 v[16:17], v[16:17], v[130:131]
    s_waitcnt lgkmcnt(5)
    v_pk_add_f32 v[132:133], v[132:133], v[136:137]
    v_pk_add_f32 v[134:135], v[134:135], v[138:139]
    s_waitcnt lgkmcnt(4)
    v_pk_add_f32 v[14:15], v[14:15], v[140:141]
    v_pk_add_f32 v[16:17], v[16:17], v[142:143]
    s_waitcnt lgkmcnt(3)
    v_pk_add_f32 v[132:133], v[132:133], v[144:145]
    v_pk_add_f32 v[134:135], v[134:135], v[146:147]
    s_waitcnt lgkmcnt(2)
    v_pk_add_f32 v[14:15], v[14:15], v[148:149]
    v_pk_add_f32 v[16:17], v[16:17], v[150:151]
    s_waitcnt lgkmcnt(1)
    v_pk_add_f32 v[132:133], v[132:133], v[152:153]
    v_pk_add_f32 v[134:135], v[134:135], v[154:155]
    s_waitcnt lgkmcnt(0)
    v_pk_add_f32 v[14:15], v[14:15], v[156:157]
    v_pk_add_f32 v[16:17], v[16:17], v[158:159]
    v_pk_add_f32 v[14:15], v[14:15], v[132:133]
    v_pk_add_f32 v[16:17], v[16:17], v[134:135]
    v_cvt_pk_bf16_f32 v14, v14, v15
    v_cvt_pk_bf16_f32 v15, v16, v17
    buffer_store_dwordx2 v[14:15], v20, s[8:11], s66 offen sc1
    s_branch Ltj
Ltl:
    v_mfma_f32_32x32x16_bf16 v[80:95], v[236:239], v[212:215], v[80:95]
    ds_read_b32 v179, v31 offset:4
    ds_write_addtid_b32 v71 offset:59388
    ds_write_addtid_b32 v72 offset:59644
    ds_write_addtid_b32 v73 offset:59900
    v_mfma_f32_32x32x16_bf16 v[80:95], v[240:243], v[220:223], v[80:95]
    ds_write_addtid_b32 v74 offset:60156
    ds_write_addtid_b32 v75 offset:60412
    ds_write_addtid_b32 v76 offset:60668
    v_mfma_f32_32x32x16_bf16 v[80:95], v[244:247], v[24:27], v[80:95]
    s_waitcnt lgkmcnt(6)
    v_readfirstlane_b32 s3, v179
    s_nop 0
    s_cmp_eq_u32 s3, 8
    s_cbranch_scc0 Lsl_67
Lok_65:
    ds_write_addtid_b32 v77 offset:60924
    ds_write_addtid_b32 v78 offset:61180
    ds_write_addtid_b32 v79 offset:61436
    ds_read_b64 v[160:161], v3 offset:512
    ds_read_b64 v[162:163], v3
    ds_read_b128 v[128:131], v28 offset:0
    ds_read_b128 v[132:135], v28 offset:8192
    ds_read_b128 v[136:139], v28 offset:16384
    ds_read_b128 v[140:143], v28 offset:24576
    ds_read_b128 v[144:147], v28 offset:32768
    ds_read_b128 v[148:151], v28 offset:40960
    ds_read_b128 v[152:155], v28 offset:49152
    ds_read_b128 v[156:159], v28 offset:57344
    v_mfma_f32_32x32x16_bf16 v[80:95], v[248:251], v[60:63], v[80:95]
    s_nop 11
    ds_write_addtid_b32 v80 offset:61692
    ds_write_addtid_b32 v81 offset:61948
    ds_write_addtid_b32 v82 offset:62204
    ds_write_addtid_b32 v83 offset:62460
    ds_write_addtid_b32 v84 offset:62716
    ds_write_addtid_b32 v85 offset:62972
    ds_write_addtid_b32 v86 offset:63228
    ds_write_addtid_b32 v87 offset:63484
    ds_write_addtid_b32 v88 offset:63740
    ds_write_addtid_b32 v89 offset:63996
    ds_write_addtid_b32 v90 offset:64252
    ds_write_addtid_b32 v91 offset:64508
    ds_write_addtid_b32 v92 offset:64764
    ds_write_addtid_b32 v93 offset:65020
    ds_write_addtid_b32 v94 offset:65276
    ds_write_addtid_b32 v95 offset:65532
    s_waitcnt lgkmcnt(15)
    v_lshlrev_b32 v164, 16, v160
    v_and_b32 v165, 0xffff0000, v160
    v_lshlrev_b32 v166, 16, v161
    v_and_b32 v167, 0xffff0000, v161
    v_pk_add_f32 v[4:5], v[4:5], v[164:165]
    v_pk_add_f32 v[6:7], v[6:7], v[166:167]
    v_lshlrev_b32 v164, 16, v162
    v_and_b32 v165, 0xffff0000, v162
    v_lshlrev_b32 v166, 16, v163
    v_and_b32 v167, 0xffff0000, v163
    v_pk_add_f32 v[14:15], v[14:15], v[164:165]
    v_pk_add_f32 v[16:17], v[16:17], v[166:167]
    v_pk_add_f32 v[4:5], v[4:5], v[128:129]
    v_pk_add_f32 v[6:7], v[6:7], v[130:131]
    v_pk_add_f32 v[132:133], v[132:133], v[136:137]
    v_pk_add_f32 v[134:135], v[134:135], v[138:139]
    v_pk_add_f32 v[4:5], v[4:5], v[140:141]
    v_pk_add_f32 v[6:7], v[6:7], v[142:143]
    v_pk_add_f32 v[132:133], v[132:133], v[144:145]
    v_pk_add_f32 v[134:135], v[134:135], v[146:147]
    v_pk_add_f32 v[4:5], v[4:5], v[148:149]
    v_pk_add_f32 v[6:7], v[6:7], v[150:151]
    v_pk_add_f32 v[132:133], v[132:133], v[152:153]
    v_pk_add_f32 v[134:135], v[134:135], v[154:155]
    v_pk_add_f32 v[4:5], v[4:5], v[156:157]
    v_pk_add_f32 v[6:7], v[6:7], v[158:159]
    v_pk_add_f32 v[4:5], v[4:5], v[132:133]
    v_pk_add_f32 v[6:7], v[6:7], v[134:135]
    v_cvt_pk_bf16_f32 v4, v4, v5
    v_cvt_pk_bf16_f32 v5, v6, v7
    buffer_store_dwordx2 v[4:5], v20, s[8:11], s64 offen sc1
    s_waitcnt lgkmcnt(0)
    s_barrier
    ds_read_b128 v[96:99], v1 offset:0
    ds_read_b128 v[100:103], v1 offset:8192
    ds_read_b128 v[104:107], v1 offset:16384
    ds_read_b128 v[108:111], v1 offset:24576
    ds_read_b128 v[112:115], v1 offset:32768
    ds_read_b128 v[116:119], v1 offset:40960
    ds_read_b128 v[120:123], v1 offset:49152
    ds_read_b128 v[124:127], v1 offset:57344
    s_waitcnt lgkmcnt(7)
    v_pk_add_f32 v[14:15], v[14:15], v[96:97]
    v_pk_add_f32 v[16:17], v[16:17], v[98:99]
    s_waitcnt lgkmcnt(5)
    v_pk_add_f32 v[100:101], v[100:101], v[104:105]
    v_pk_add_f32 v[102:103], v[102:103], v[106:107]
    s_waitcnt lgkmcnt(4)
    v_pk_add_f32 v[14:15], v[14:15], v[108:109]
    v_pk_add_f32 v[16:17], v[16:17], v[110:111]
    s_waitcnt lgkmcnt(3)
    v_pk_add_f32 v[100:101], v[100:101], v[112:113]
    v_pk_add_f32 v[102:103], v[102:103], v[114:115]
    s_waitcnt lgkmcnt(2)
    v_pk_add_f32 v[14:15], v[14:15], v[116:117]
    v_pk_add_f32 v[16:17], v[16:17], v[118:119]
    s_waitcnt lgkmcnt(1)
    v_pk_add_f32 v[100:101], v[100:101], v[120:121]
    v_pk_add_f32 v[102:103], v[102:103], v[122:123]
    s_waitcnt lgkmcnt(0)
    v_pk_add_f32 v[14:15], v[14:15], v[124:125]
    v_pk_add_f32 v[16:17], v[16:17], v[126:127]
    v_pk_add_f32 v[14:15], v[14:15], v[100:101]
    v_pk_add_f32 v[16:17], v[16:17], v[102:103]
    v_cvt_pk_bf16_f32 v14, v14, v15
    v_cvt_pk_bf16_f32 v15, v16, v17
    buffer_store_dwordx2 v[14:15], v20, s[8:11], s66 offen sc1
Ltj:
parallel_sum__ssm_conv_s4__geglu_ffn__prompt_kernel_end:
    s_endpgm
Lrole:
    s_lshl_b32 s48, s68, 1
    s_lshr_b32 s3, s96, 2
    s_add_u32 s48, s48, s3
    s_lshl_b32 s48, s48, 2
    s_add_u32 s48, s48, s97
    s_lshl_b32 s48, s48, 3
    s_add_u32 s48, s48, s101
    s_lshl_b32 s3, s48, 13
    v_lshl_or_b32 v3, v8, 10, v9
    buffer_load_dwordx4 v[160:163], v3, s[4:7], s3 offen offset:0
    buffer_load_dwordx4 v[164:167], v3, s[4:7], s3 offen offset:128
    buffer_load_dwordx4 v[168:171], v3, s[4:7], s3 offen offset:256
    buffer_load_dwordx4 v[172:175], v3, s[4:7], s3 offen offset:384
    buffer_load_dwordx4 v[176:179], v3, s[4:7], s3 offen offset:512
    buffer_load_dwordx4 v[180:183], v3, s[4:7], s3 offen offset:640
    buffer_load_dwordx4 v[184:187], v3, s[4:7], s3 offen offset:768
    buffer_load_dwordx4 v[188:191], v3, s[4:7], s3 offen offset:896
    global_load_short_d16_hi v208, v14, s[18:19]
    global_load_short_d16_hi v209, v14, s[20:21]
    s_cmp_lt_u32 s101, 4
    s_cbranch_scc1 Lo_1
    global_load_short_d16_hi v210, v14, s[22:23]
    global_load_short_d16_hi v211, v14, s[24:25]
    global_load_short_d16_hi v212, v14, s[26:27]
    global_load_short_d16_hi v213, v14, s[28:29]
Lo_1:
    s_lshl_b32 s3, s50, 2
    s_load_dword s92, s[30:31], s3
    s_load_dword s93, s[32:33], s3
    s_add_u32 s51, s96, 1
    s_and_b32 s51, s51, 3
    s_lshl_b32 s51, s51, 3
    s_and_b32 s3, s96, 4
    s_add_u32 s51, s51, s3
    s_and_b32 s3, s97, 3
    s_add_u32 s51, s51, s3
    s_lshr_b32 s52, s97, 2
    s_lshr_b32 s67, s101, 2
    s_and_b32 s90, s101, 3
    s_lshl_b32 s65, s52, 4
    s_add_u32 s65, s65, s101
    s_mul_i32 s65, s65, 14336
    s_add_u32 s65, s65, 14680064
    v_and_b32 v26, 16, v0
    v_lshrrev_b32 v27, 5, v0
    v_bfe_u32 v23, v0, 2, 2
    v_lshl_add_u32 v24, v27, 3, v23
    v_lshlrev_b32 v25, 4, v1
    v_and_b32 v23, 2, v0
    v_lshl_or_b32 v25, v23, 2, v25
    s_mov_b32 s95, 1
    v_mul_u32_u24 v4, 1056, v8
    v_add_u32 v4, v4, v9
    s_mul_i32 s3, s101, 8576
    v_add_u32 v4, s3, v4
    v_bfe_u32 v5, v0, 2, 2
    v_mul_u32_u24 v5, 1056, v5
    v_mul_u32_u24 v6, 8576, v1
    v_add_u32 v5, v5, v6
    v_and_b32 v6, 2, v0
    v_lshl_add_u32 v5, v6, 2, v5
    v_and_b32 v6, 48, v0
    v_add_u32 v5, v5, v6
    s_and_b32 s3, s101, 6
    s_mul_i32 s3, s3, 8576
    s_and_b32 s98, s101, 1
    s_lshl_b32 s98, s98, 9
    s_add_u32 s3, s3, s98
    v_add_u32 v5, s3, v5
    v_lshlrev_b32 v6, 3, v8
    v_mov_b32 v144, -1
    v_mov_b32 v145, -1
    v_mov_b32 v146, -1
    v_mov_b32 v147, -1
    s_andn2_b32 s40, s48, 3
    s_add_u32 s40, s40, s48
    s_mul_i32 s40, s40, 14336
    s_add_u32 s40, s40, 4251648
    s_lshl_b32 s41, s48, 13
    s_add_u32 s41, s41, 12582912
    s_and_b32 s68, s101, 1
    s_bfe_u32 s69, s101, 0x10001
    s_mul_i32 s94, s68, 28512
    s_add_u32 s94, s94, 98304
    v_and_b32 v38, 15, v0
    v_mul_u32_u24 v33, 528, v38
    v_and_b32 v39, 16, v0
    v_lshl_add_u32 v33, v39, 4, v33
    v_and_b32 v39, 32, v0
    v_lshl_add_u32 v33, v39, 2, v33
    s_mul_i32 s3, s69, 8448
    s_add_u32 s3, s3, s94
    v_add_u32 v32, s3, v33
    s_mul_i32 s3, s67, 8448
    s_add_u32 s3, s3, s94
    s_add_u32 s3, s3, 11616
    v_add_u32 v33, s3, v33
    s_waitcnt lgkmcnt(0)
    s_add_u32 s100, s100, 1
    s_waitcnt vmcnt(9)
    v_lshlrev_b32 v64, 16, v160
    v_and_b32 v65, 0xffff0000, v160
    v_lshlrev_b32 v66, 16, v161
    v_and_b32 v67, 0xffff0000, v161
    v_lshlrev_b32 v68, 16, v162
    v_and_b32 v69, 0xffff0000, v162
    v_lshlrev_b32 v70, 16, v163
    v_and_b32 v71, 0xffff0000, v163
    s_waitcnt vmcnt(8)
    v_lshlrev_b32 v72, 16, v164
    v_and_b32 v73, 0xffff0000, v164
    v_lshlrev_b32 v74, 16, v165
    v_and_b32 v75, 0xffff0000, v165
    v_lshlrev_b32 v76, 16, v166
    v_and_b32 v77, 0xffff0000, v166
    v_lshlrev_b32 v78, 16, v167
    v_and_b32 v79, 0xffff0000, v167
    v_pk_add_f32 v[128:129], v[64:65], v[72:73]
    v_pk_add_f32 v[130:131], v[66:67], v[74:75]
    v_pk_add_f32 v[132:133], v[68:69], v[76:77]
    v_pk_add_f32 v[134:135], v[70:71], v[78:79]
    s_waitcnt vmcnt(7)
    v_lshlrev_b32 v80, 16, v168
    v_and_b32 v81, 0xffff0000, v168
    v_lshlrev_b32 v82, 16, v169
    v_and_b32 v83, 0xffff0000, v169
    v_lshlrev_b32 v84, 16, v170
    v_and_b32 v85, 0xffff0000, v170
    v_lshlrev_b32 v86, 16, v171
    v_and_b32 v87, 0xffff0000, v171
    v_pk_add_f32 v[128:129], v[128:129], v[80:81]
    v_pk_add_f32 v[130:131], v[130:131], v[82:83]
    v_pk_add_f32 v[132:133], v[132:133], v[84:85]
    v_pk_add_f32 v[134:135], v[134:135], v[86:87]
    s_waitcnt vmcnt(6)
    v_lshlrev_b32 v88, 16, v172
    v_and_b32 v89, 0xffff0000, v172
    v_lshlrev_b32 v90, 16, v173
    v_and_b32 v91, 0xffff0000, v173
    v_lshlrev_b32 v92, 16, v174
    v_and_b32 v93, 0xffff0000, v174
    v_lshlrev_b32 v94, 16, v175
    v_and_b32 v95, 0xffff0000, v175
    v_pk_add_f32 v[128:129], v[128:129], v[88:89]
    v_pk_add_f32 v[130:131], v[130:131], v[90:91]
    v_pk_add_f32 v[132:133], v[132:133], v[92:93]
    v_pk_add_f32 v[134:135], v[134:135], v[94:95]
    s_waitcnt vmcnt(5)
    v_lshlrev_b32 v96, 16, v176
    v_and_b32 v97, 0xffff0000, v176
    v_lshlrev_b32 v98, 16, v177
    v_and_b32 v99, 0xffff0000, v177
    v_lshlrev_b32 v100, 16, v178
    v_and_b32 v101, 0xffff0000, v178
    v_lshlrev_b32 v102, 16, v179
    v_and_b32 v103, 0xffff0000, v179
    v_pk_add_f32 v[128:129], v[128:129], v[96:97]
    v_pk_add_f32 v[130:131], v[130:131], v[98:99]
    v_pk_add_f32 v[132:133], v[132:133], v[100:101]
    v_pk_add_f32 v[134:135], v[134:135], v[102:103]
    s_waitcnt vmcnt(4)
    v_lshlrev_b32 v104, 16, v180
    v_and_b32 v105, 0xffff0000, v180
    v_lshlrev_b32 v106, 16, v181
    v_and_b32 v107, 0xffff0000, v181
    v_lshlrev_b32 v108, 16, v182
    v_and_b32 v109, 0xffff0000, v182
    v_lshlrev_b32 v110, 16, v183
    v_and_b32 v111, 0xffff0000, v183
    v_pk_add_f32 v[128:129], v[128:129], v[104:105]
    v_pk_add_f32 v[130:131], v[130:131], v[106:107]
    v_pk_add_f32 v[132:133], v[132:133], v[108:109]
    v_pk_add_f32 v[134:135], v[134:135], v[110:111]
    s_waitcnt vmcnt(3)
    v_lshlrev_b32 v112, 16, v184
    v_and_b32 v113, 0xffff0000, v184
    v_lshlrev_b32 v114, 16, v185
    v_and_b32 v115, 0xffff0000, v185
    v_lshlrev_b32 v116, 16, v186
    v_and_b32 v117, 0xffff0000, v186
    v_lshlrev_b32 v118, 16, v187
    v_and_b32 v119, 0xffff0000, v187
    v_pk_add_f32 v[128:129], v[128:129], v[112:113]
    v_pk_add_f32 v[130:131], v[130:131], v[114:115]
    v_pk_add_f32 v[132:133], v[132:133], v[116:117]
    v_pk_add_f32 v[134:135], v[134:135], v[118:119]
    s_waitcnt vmcnt(2)
    v_lshlrev_b32 v120, 16, v188
    v_and_b32 v121, 0xffff0000, v188
    v_lshlrev_b32 v122, 16, v189
    v_and_b32 v123, 0xffff0000, v189
    v_lshlrev_b32 v124, 16, v190
    v_and_b32 v125, 0xffff0000, v190
    v_lshlrev_b32 v126, 16, v191
    v_and_b32 v127, 0xffff0000, v191
    v_pk_add_f32 v[128:129], v[128:129], v[120:121]
    v_pk_add_f32 v[130:131], v[130:131], v[122:123]
    v_pk_add_f32 v[132:133], v[132:133], v[124:125]
    v_pk_add_f32 v[134:135], v[134:135], v[126:127]
    v_pk_add_f32 v[128:129], v[128:129], v[130:131]
    v_pk_add_f32 v[132:133], v[132:133], v[134:135]
    v_pk_add_f32 v[128:129], v[128:129], v[132:133]
    v_add_f32 v136, v128, v129
    s_nop 1
    v_add_f32_dpp v136, v136, v136 quad_perm:[1,0,3,2] row_mask:0xf bank_mask:0xf
    s_nop 1
    v_add_f32_dpp v136, v136, v136 quad_perm:[2,3,0,1] row_mask:0xf bank_mask:0xf
    s_nop 1
    v_add_f32_dpp v136, v136, v136 row_half_mirror row_mask:0xf bank_mask:0xf
    v_mul_f32 v136, 0x3b000000, v136
    v_cvt_pk_bf16_f32 v140, v136, v136
    v_xor_b32 v140, 0x80008000, v140
    v_and_b32 v138, 0xffff0000, v140
    v_and_b32 v139, 0xffff0000, v140
    v_add_f32 v136, v136, v138
    v_pk_add_f32 v[64:65], v[64:65], v[138:139]
    v_pk_add_f32 v[66:67], v[66:67], v[138:139]
    v_pk_mul_f32 v[128:129], v[64:65], v[64:65]
    v_pk_add_f32 v[68:69], v[68:69], v[138:139]
    v_pk_mul_f32 v[130:131], v[66:67], v[66:67]
    v_pk_add_f32 v[70:71], v[70:71], v[138:139]
    v_pk_mul_f32 v[132:133], v[68:69], v[68:69]
    v_pk_add_f32 v[72:73], v[72:73], v[138:139]
    v_pk_mul_f32 v[134:135], v[70:71], v[70:71]
    v_pk_add_f32 v[74:75], v[74:75], v[138:139]
    v_pk_fma_f32 v[128:129], v[72:73], v[72:73], v[128:129]
    v_pk_add_f32 v[76:77], v[76:77], v[138:139]
    v_pk_fma_f32 v[130:131], v[74:75], v[74:75], v[130:131]
    v_pk_add_f32 v[78:79], v[78:79], v[138:139]
    v_pk_fma_f32 v[132:133], v[76:77], v[76:77], v[132:133]
    v_pk_add_f32 v[80:81], v[80:81], v[138:139]
    v_pk_fma_f32 v[134:135], v[78:79], v[78:79], v[134:135]
    v_pk_add_f32 v[82:83], v[82:83], v[138:139]
    v_pk_fma_f32 v[128:129], v[80:81], v[80:81], v[128:129]
    v_pk_add_f32 v[84:85], v[84:85], v[138:139]
    v_pk_fma_f32 v[130:131], v[82:83], v[82:83], v[130:131]
    v_pk_add_f32 v[86:87], v[86:87], v[138:139]
    v_pk_fma_f32 v[132:133], v[84:85], v[84:85], v[132:133]
    v_pk_add_f32 v[88:89], v[88:89], v[138:139]
    v_pk_fma_f32 v[134:135], v[86:87], v[86:87], v[134:135]
    v_pk_add_f32 v[90:91], v[90:91], v[138:139]
    v_pk_fma_f32 v[128:129], v[88:89], v[88:89], v[128:129]
    v_pk_add_f32 v[92:93], v[92:93], v[138:139]
    v_pk_fma_f32 v[130:131], v[90:91], v[90:91], v[130:131]
    v_pk_add_f32 v[94:95], v[94:95], v[138:139]
    v_pk_fma_f32 v[132:133], v[92:93], v[92:93], v[132:133]
    v_pk_add_f32 v[96:97], v[96:97], v[138:139]
    v_pk_fma_f32 v[134:135], v[94:95], v[94:95], v[134:135]
    v_pk_add_f32 v[98:99], v[98:99], v[138:139]
    v_pk_fma_f32 v[128:129], v[96:97], v[96:97], v[128:129]
    v_pk_add_f32 v[100:101], v[100:101], v[138:139]
    v_pk_fma_f32 v[130:131], v[98:99], v[98:99], v[130:131]
    v_pk_add_f32 v[102:103], v[102:103], v[138:139]
    v_pk_fma_f32 v[132:133], v[100:101], v[100:101], v[132:133]
    v_pk_add_f32 v[104:105], v[104:105], v[138:139]
    v_pk_fma_f32 v[134:135], v[102:103], v[102:103], v[134:135]
    v_pk_add_f32 v[106:107], v[106:107], v[138:139]
    v_pk_fma_f32 v[128:129], v[104:105], v[104:105], v[128:129]
    v_pk_add_f32 v[108:109], v[108:109], v[138:139]
    v_pk_fma_f32 v[130:131], v[106:107], v[106:107], v[130:131]
    v_pk_add_f32 v[110:111], v[110:111], v[138:139]
    v_pk_fma_f32 v[132:133], v[108:109], v[108:109], v[132:133]
    v_pk_add_f32 v[112:113], v[112:113], v[138:139]
    v_pk_fma_f32 v[134:135], v[110:111], v[110:111], v[134:135]
    v_pk_add_f32 v[114:115], v[114:115], v[138:139]
    v_pk_fma_f32 v[128:129], v[112:113], v[112:113], v[128:129]
    v_pk_add_f32 v[116:117], v[116:117], v[138:139]
    v_pk_fma_f32 v[130:131], v[114:115], v[114:115], v[130:131]
    v_pk_add_f32 v[118:119], v[118:119], v[138:139]
    v_pk_fma_f32 v[132:133], v[116:117], v[116:117], v[132:133]
    v_pk_add_f32 v[120:121], v[120:121], v[138:139]
    v_pk_fma_f32 v[134:135], v[118:119], v[118:119], v[134:135]
    v_pk_add_f32 v[122:123], v[122:123], v[138:139]
    v_pk_fma_f32 v[128:129], v[120:121], v[120:121], v[128:129]
    v_pk_add_f32 v[124:125], v[124:125], v[138:139]
    v_pk_fma_f32 v[130:131], v[122:123], v[122:123], v[130:131]
    v_pk_add_f32 v[126:127], v[126:127], v[138:139]
    v_pk_fma_f32 v[132:133], v[124:125], v[124:125], v[132:133]
    v_pk_fma_f32 v[134:135], v[126:127], v[126:127], v[134:135]
    v_pk_add_f32 v[128:129], v[128:129], v[130:131]
    v_pk_add_f32 v[132:133], v[132:133], v[134:135]
    v_pk_add_f32 v[128:129], v[128:129], v[132:133]
    v_add_f32 v137, v128, v129
    s_nop 1
    v_add_f32_dpp v137, v137, v137 quad_perm:[1,0,3,2] row_mask:0xf bank_mask:0xf
    s_nop 1
    v_add_f32_dpp v137, v137, v137 quad_perm:[2,3,0,1] row_mask:0xf bank_mask:0xf
    s_nop 1
    v_add_f32_dpp v137, v137, v137 row_half_mirror row_mask:0xf bank_mask:0xf
    v_mul_f32 v137, 0x3b000000, v137
    v_fma_f32 v137, -v136, v136, v137
    v_max_f32 v137, 0, v137
    v_cvt_pk_bf16_f32 v137, v137, v137
    v_and_b32 v137, 0xffff0000, v137
    v_add_f32 v137, 0x3727c5ac, v137
    v_cvt_pk_bf16_f32 v137, v137, v137
    v_and_b32 v137, 0xffff0000, v137
    v_sqrt_f32 v137, v137
    v_and_b32 v142, 0xffff, v140
    v_mov_b32 v143, s100
    v_cvt_pk_bf16_f32 v137, v137, v137
    v_and_b32 v141, 0xffff0000, v137
    v_rcp_f32 v138, v141
    v_or_b32 v142, v142, v141
    s_lshl_b32 s3, s48, 6
    s_mov_b32 exec_lo, 0x01010101
    s_mov_b32 exec_hi, 0x01010101
    buffer_store_dwordx2 v[142:143], v6, s[56:59], s3 offen sc1
    s_mov_b64 exec, -1
    v_fma_f32 v139, -v141, v138, 1.0
    v_fmac_f32 v138, v139, v138
    v_mov_b32 v139, v138
    v_pk_mul_f32 v[64:65], v[64:65], v[138:139]
    v_pk_mul_f32 v[66:67], v[66:67], v[138:139]
    v_pk_mul_f32 v[68:69], v[68:69], v[138:139]
    v_pk_mul_f32 v[70:71], v[70:71], v[138:139]
    v_cvt_pk_bf16_f32 v160, v64, v65
    v_cvt_pk_bf16_f32 v161, v66, v67
    v_cvt_pk_bf16_f32 v162, v68, v69
    v_cvt_pk_bf16_f32 v163, v70, v71
    ds_write_b128 v4, v[160:163] offset:0
    v_pk_mul_f32 v[72:73], v[72:73], v[138:139]
    v_pk_mul_f32 v[74:75], v[74:75], v[138:139]
    v_pk_mul_f32 v[76:77], v[76:77], v[138:139]
    v_pk_mul_f32 v[78:79], v[78:79], v[138:139]
    v_cvt_pk_bf16_f32 v164, v72, v73
    v_cvt_pk_bf16_f32 v165, v74, v75
    v_cvt_pk_bf16_f32 v166, v76, v77
    v_cvt_pk_bf16_f32 v167, v78, v79
    ds_write_b128 v4, v[164:167] offset:128
    v_pk_mul_f32 v[80:81], v[80:81], v[138:139]
    v_pk_mul_f32 v[82:83], v[82:83], v[138:139]
    v_pk_mul_f32 v[84:85], v[84:85], v[138:139]
    v_pk_mul_f32 v[86:87], v[86:87], v[138:139]
    v_cvt_pk_bf16_f32 v168, v80, v81
    v_cvt_pk_bf16_f32 v169, v82, v83
    v_cvt_pk_bf16_f32 v170, v84, v85
    v_cvt_pk_bf16_f32 v171, v86, v87
    ds_write_b128 v4, v[168:171] offset:256
    v_pk_mul_f32 v[88:89], v[88:89], v[138:139]
    v_pk_mul_f32 v[90:91], v[90:91], v[138:139]
    v_pk_mul_f32 v[92:93], v[92:93], v[138:139]
    v_pk_mul_f32 v[94:95], v[94:95], v[138:139]
    v_cvt_pk_bf16_f32 v172, v88, v89
    v_cvt_pk_bf16_f32 v173, v90, v91
    v_cvt_pk_bf16_f32 v174, v92, v93
    v_cvt_pk_bf16_f32 v175, v94, v95
    ds_write_b128 v4, v[172:175] offset:384
    v_pk_mul_f32 v[96:97], v[96:97], v[138:139]
    v_pk_mul_f32 v[98:99], v[98:99], v[138:139]
    v_pk_mul_f32 v[100:101], v[100:101], v[138:139]
    v_pk_mul_f32 v[102:103], v[102:103], v[138:139]
    v_cvt_pk_bf16_f32 v176, v96, v97
    v_cvt_pk_bf16_f32 v177, v98, v99
    v_cvt_pk_bf16_f32 v178, v100, v101
    v_cvt_pk_bf16_f32 v179, v102, v103
    ds_write_b128 v4, v[176:179] offset:512
    v_pk_mul_f32 v[104:105], v[104:105], v[138:139]
    v_pk_mul_f32 v[106:107], v[106:107], v[138:139]
    v_pk_mul_f32 v[108:109], v[108:109], v[138:139]
    v_pk_mul_f32 v[110:111], v[110:111], v[138:139]
    v_cvt_pk_bf16_f32 v180, v104, v105
    v_cvt_pk_bf16_f32 v181, v106, v107
    v_cvt_pk_bf16_f32 v182, v108, v109
    v_cvt_pk_bf16_f32 v183, v110, v111
    ds_write_b128 v4, v[180:183] offset:640
    v_pk_mul_f32 v[112:113], v[112:113], v[138:139]
    v_pk_mul_f32 v[114:115], v[114:115], v[138:139]
    v_pk_mul_f32 v[116:117], v[116:117], v[138:139]
    v_pk_mul_f32 v[118:119], v[118:119], v[138:139]
    v_cvt_pk_bf16_f32 v184, v112, v113
    v_cvt_pk_bf16_f32 v185, v114, v115
    v_cvt_pk_bf16_f32 v186, v116, v117
    v_cvt_pk_bf16_f32 v187, v118, v119
    ds_write_b128 v4, v[184:187] offset:768
    v_pk_mul_f32 v[120:121], v[120:121], v[138:139]
    v_pk_mul_f32 v[122:123], v[122:123], v[138:139]
    v_pk_mul_f32 v[124:125], v[124:125], v[138:139]
    v_pk_mul_f32 v[126:127], v[126:127], v[138:139]
    v_cvt_pk_bf16_f32 v188, v120, v121
    v_cvt_pk_bf16_f32 v189, v122, v123
    v_cvt_pk_bf16_f32 v190, v124, v125
    v_cvt_pk_bf16_f32 v191, v126, v127
    ds_write_b128 v4, v[188:191] offset:896
    s_waitcnt lgkmcnt(0)
    s_barrier
    ds_read_b64_tr_b16 v[64:65], v5 offset:0
    ds_read_b64_tr_b16 v[66:67], v5 offset:4224
    ds_read_b64_tr_b16 v[68:69], v5 offset:64
    ds_read_b64_tr_b16 v[70:71], v5 offset:4288
    ds_read_b64_tr_b16 v[72:73], v5 offset:128
    ds_read_b64_tr_b16 v[74:75], v5 offset:4352
    ds_read_b64_tr_b16 v[76:77], v5 offset:192
    ds_read_b64_tr_b16 v[78:79], v5 offset:4416
    ds_read_b64_tr_b16 v[80:81], v5 offset:256
    ds_read_b64_tr_b16 v[82:83], v5 offset:4480
    ds_read_b64_tr_b16 v[84:85], v5 offset:320
    ds_read_b64_tr_b16 v[86:87], v5 offset:4544
    ds_read_b64_tr_b16 v[88:89], v5 offset:384
    ds_read_b64_tr_b16 v[90:91], v5 offset:4608
    ds_read_b64_tr_b16 v[92:93], v5 offset:448
    ds_read_b64_tr_b16 v[94:95], v5 offset:4672
    s_lshl_b32 s98, s48, 13
    s_add_u32 s98, s98, 0x200000
    s_add_u32 s99, s98, 4096
    s_waitcnt lgkmcnt(14)
    buffer_store_dwordx4 v[64:67], v2, s[56:59], s98 offen offset:0 sc1
    s_waitcnt lgkmcnt(12)
    buffer_store_dwordx4 v[68:71], v2, s[56:59], s98 offen offset:1024 sc1
    s_waitcnt lgkmcnt(10)
    buffer_store_dwordx4 v[72:75], v2, s[56:59], s98 offen offset:2048 sc1
    s_waitcnt lgkmcnt(8)
    buffer_store_dwordx4 v[76:79], v2, s[56:59], s98 offen offset:3072 sc1
    s_waitcnt lgkmcnt(6)
    buffer_store_dwordx4 v[80:83], v2, s[56:59], s99 offen offset:0 sc1
    s_waitcnt lgkmcnt(4)
    buffer_store_dwordx4 v[84:87], v2, s[56:59], s99 offen offset:1024 sc1
    s_waitcnt lgkmcnt(2)
    buffer_store_dwordx4 v[88:91], v2, s[56:59], s99 offen offset:2048 sc1
    s_waitcnt lgkmcnt(0)
    buffer_store_dwordx4 v[92:95], v2, s[56:59], s99 offen offset:3072 sc1
    s_lshl_b32 s3, s68, 4
    s_lshr_b32 s92, s92, s3
    s_lshl_b32 s92, s92, 16
    v_mov_b32 v214, 0x3fb8aa00
    v_mov_b32 v215, 0x36eca570
    v_mul_f32 v214, s92, v214
    v_mul_f32 v215, s92, v215
    v_exp_f32 v214, v214
    v_exp_f32 v215, v215
    s_lshl_b32 s3, s69, 8
    s_add_u32 s3, s3, s94
    v_lshl_add_u32 v1, v0, 2, s3
    v_mul_f32 v214, v214, v215
    v_cvt_pk_bf16_f32 v214, v214, v214
    v_and_b32 v214, 0xffff0000, v214
    s_waitcnt vmcnt(10)
    v_mul_f32 v208, v214, v208
    s_waitcnt vmcnt(9)
    v_mul_f32 v209, v214, v209
    s_cmp_ge_u32 s101, 4
    s_cbranch_scc1 Lk1
    v_mul_f32 v220, 0x4138aa3b, v208
    v_mul_f32 v221, 0x3fa2f983, v209
    v_exp_f32 v220, v220
    v_fract_f32 v221, v221
    v_cos_f32 v226, v221
    v_sin_f32 v227, v221
    v_mul_f32 v226, v226, v220
    v_mul_f32 v227, v227, v220
    v_mov_b32 v216, 0x3f80
    ds_write_b32 v1, v216 offset:11616
    v_pk_mul_f32 v[228:229], v[226:227], v[226:227] op_sel:[0,0] op_sel_hi:[1,0]
    v_pk_fma_f32 v[228:229], v[226:227], v[226:227], v[228:229] op_sel:[1,1,0] op_sel_hi:[0,1,1] neg_lo:[1,0,0]
    v_cvt_pk_bf16_f32 v217, v226, v227
    ds_write_b32 v1, v217 offset:12144
    v_pk_mul_f32 v[230:231], v[228:229], v[226:227] op_sel:[0,0] op_sel_hi:[1,0]
    v_pk_fma_f32 v[230:231], v[228:229], v[226:227], v[230:231] op_sel:[1,1,0] op_sel_hi:[0,1,1] neg_lo:[1,0,0]
    v_pk_mul_f32 v[222:223], v[228:229], v[228:229] op_sel:[0,0] op_sel_hi:[1,0]
    v_pk_fma_f32 v[222:223], v[228:229], v[228:229], v[222:223] op_sel:[1,1,0] op_sel_hi:[0,1,1] neg_lo:[1,0,0]
    v_cvt_pk_bf16_f32 v218, v228, v229
    ds_write_b32 v1, v218 offset:12672
    v_cvt_pk_bf16_f32 v219, v230, v231
    ds_write_b32 v1, v219 offset:13200
    v_cvt_pk_bf16_f32 v216, v222, v223
    ds_write_b32 v1, v216 offset:13728
    v_pk_mul_f32 v[234:235], v[226:227], v[222:223] op_sel:[0,0] op_sel_hi:[1,0]
    v_pk_fma_f32 v[234:235], v[226:227], v[222:223], v[234:235] op_sel:[1,1,0] op_sel_hi:[0,1,1] neg_lo:[1,0,0]
    v_pk_mul_f32 v[236:237], v[228:229], v[222:223] op_sel:[0,0] op_sel_hi:[1,0]
    v_pk_fma_f32 v[236:237], v[228:229], v[222:223], v[236:237] op_sel:[1,1,0] op_sel_hi:[0,1,1] neg_lo:[1,0,0]
    v_cvt_pk_bf16_f32 v217, v234, v235
    ds_write_b32 v1, v217 offset:14256
    v_pk_mul_f32 v[238:239], v[230:231], v[222:223] op_sel:[0,0] op_sel_hi:[1,0]
    v_pk_fma_f32 v[238:239], v[230:231], v[222:223], v[238:239] op_sel:[1,1,0] op_sel_hi:[0,1,1] neg_lo:[1,0,0]
    v_cvt_pk_bf16_f32 v218, v236, v237
    ds_write_b32 v1, v218 offset:14784
    v_pk_mul_f32 v[224:225], v[222:223], v[222:223] op_sel:[0,0] op_sel_hi:[1,0]
    v_pk_fma_f32 v[224:225], v[222:223], v[222:223], v[224:225] op_sel:[1,1,0] op_sel_hi:[0,1,1] neg_lo:[1,0,0]
    v_cvt_pk_bf16_f32 v219, v238, v239
    ds_write_b32 v1, v219 offset:15312
    v_pk_mul_f32 v[226:227], v[234:235], v[222:223] op_sel:[0,0] op_sel_hi:[1,0]
    v_pk_fma_f32 v[226:227], v[234:235], v[222:223], v[226:227] op_sel:[1,1,0] op_sel_hi:[0,1,1] neg_lo:[1,0,0]
    v_cvt_pk_bf16_f32 v216, v224, v225
    ds_write_b32 v1, v216 offset:15840
    v_pk_mul_f32 v[228:229], v[236:237], v[222:223] op_sel:[0,0] op_sel_hi:[1,0]
    v_pk_fma_f32 v[228:229], v[236:237], v[222:223], v[228:229] op_sel:[1,1,0] op_sel_hi:[0,1,1] neg_lo:[1,0,0]
    v_cvt_pk_bf16_f32 v217, v226, v227
    ds_write_b32 v1, v217 offset:16368
    v_pk_mul_f32 v[230:231], v[238:239], v[222:223] op_sel:[0,0] op_sel_hi:[1,0]
    v_pk_fma_f32 v[230:231], v[238:239], v[222:223], v[230:231] op_sel:[1,1,0] op_sel_hi:[0,1,1] neg_lo:[1,0,0]
    v_cvt_pk_bf16_f32 v218, v228, v229
    ds_write_b32 v1, v218 offset:16896
    v_pk_mul_f32 v[232:233], v[224:225], v[222:223] op_sel:[0,0] op_sel_hi:[1,0]
    v_pk_fma_f32 v[232:233], v[224:225], v[222:223], v[232:233] op_sel:[1,1,0] op_sel_hi:[0,1,1] neg_lo:[1,0,0]
    v_cvt_pk_bf16_f32 v219, v230, v231
    ds_write_b32 v1, v219 offset:17424
    v_pk_mul_f32 v[234:235], v[226:227], v[222:223] op_sel:[0,0] op_sel_hi:[1,0]
    v_pk_fma_f32 v[234:235], v[226:227], v[222:223], v[234:235] op_sel:[1,1,0] op_sel_hi:[0,1,1] neg_lo:[1,0,0]
    v_cvt_pk_bf16_f32 v216, v232, v233
    ds_write_b32 v1, v216 offset:17952
    v_pk_mul_f32 v[236:237], v[228:229], v[222:223] op_sel:[0,0] op_sel_hi:[1,0]
    v_pk_fma_f32 v[236:237], v[228:229], v[222:223], v[236:237] op_sel:[1,1,0] op_sel_hi:[0,1,1] neg_lo:[1,0,0]
    v_cvt_pk_bf16_f32 v217, v234, v235
    ds_write_b32 v1, v217 offset:18480
    v_pk_mul_f32 v[238:239], v[230:231], v[222:223] op_sel:[0,0] op_sel_hi:[1,0]
    v_pk_fma_f32 v[238:239], v[230:231], v[222:223], v[238:239] op_sel:[1,1,0] op_sel_hi:[0,1,1] neg_lo:[1,0,0]
    v_cvt_pk_bf16_f32 v218, v236, v237
    ds_write_b32 v1, v218 offset:19008
    v_pk_mul_f32 v[224:225], v[232:233], v[222:223] op_sel:[0,0] op_sel_hi:[1,0]
    v_pk_fma_f32 v[224:225], v[232:233], v[222:223], v[224:225] op_sel:[1,1,0] op_sel_hi:[0,1,1] neg_lo:[1,0,0]
    v_cvt_pk_bf16_f32 v219, v238, v239
    ds_write_b32 v1, v219 offset:19536
    v_pk_mul_f32 v[226:227], v[234:235], v[222:223] op_sel:[0,0] op_sel_hi:[1,0]
    v_pk_fma_f32 v[226:227], v[234:235], v[222:223], v[226:227] op_sel:[1,1,0] op_sel_hi:[0,1,1] neg_lo:[1,0,0]
    v_cvt_pk_bf16_f32 v216, v224, v225
    ds_write_b32 v1, v216 offset:20064
    v_pk_mul_f32 v[228:229], v[236:237], v[222:223] op_sel:[0,0] op_sel_hi:[1,0]
    v_pk_fma_f32 v[228:229], v[236:237], v[222:223], v[228:229] op_sel:[1,1,0] op_sel_hi:[0,1,1] neg_lo:[1,0,0]
    v_cvt_pk_bf16_f32 v217, v226, v227
    ds_write_b32 v1, v217 offset:20592
    v_pk_mul_f32 v[230:231], v[238:239], v[222:223] op_sel:[0,0] op_sel_hi:[1,0]
    v_pk_fma_f32 v[230:231], v[238:239], v[222:223], v[230:231] op_sel:[1,1,0] op_sel_hi:[0,1,1] neg_lo:[1,0,0]
    v_cvt_pk_bf16_f32 v218, v228, v229
    ds_write_b32 v1, v218 offset:21120
    v_pk_mul_f32 v[232:233], v[224:225], v[222:223] op_sel:[0,0] op_sel_hi:[1,0]
    v_pk_fma_f32 v[232:233], v[224:225], v[222:223], v[232:233] op_sel:[1,1,0] op_sel_hi:[0,1,1] neg_lo:[1,0,0]
    v_cvt_pk_bf16_f32 v219, v230, v231
    ds_write_b32 v1, v219 offset:21648
    v_pk_mul_f32 v[234:235], v[226:227], v[222:223] op_sel:[0,0] op_sel_hi:[1,0]
    v_pk_fma_f32 v[234:235], v[226:227], v[222:223], v[234:235] op_sel:[1,1,0] op_sel_hi:[0,1,1] neg_lo:[1,0,0]
    v_cvt_pk_bf16_f32 v216, v232, v233
    ds_write_b32 v1, v216 offset:22176
    v_pk_mul_f32 v[236:237], v[228:229], v[222:223] op_sel:[0,0] op_sel_hi:[1,0]
    v_pk_fma_f32 v[236:237], v[228:229], v[222:223], v[236:237] op_sel:[1,1,0] op_sel_hi:[0,1,1] neg_lo:[1,0,0]
    v_cvt_pk_bf16_f32 v217, v234, v235
    ds_write_b32 v1, v217 offset:22704
    v_pk_mul_f32 v[238:239], v[230:231], v[222:223] op_sel:[0,0] op_sel_hi:[1,0]
    v_pk_fma_f32 v[238:239], v[230:231], v[222:223], v[238:239] op_sel:[1,1,0] op_sel_hi:[0,1,1] neg_lo:[1,0,0]
    v_cvt_pk_bf16_f32 v218, v236, v237
    ds_write_b32 v1, v218 offset:23232
    v_pk_mul_f32 v[224:225], v[232:233], v[222:223] op_sel:[0,0] op_sel_hi:[1,0]
    v_pk_fma_f32 v[224:225], v[232:233], v[222:223], v[224:225] op_sel:[1,1,0] op_sel_hi:[0,1,1] neg_lo:[1,0,0]
    v_cvt_pk_bf16_f32 v219, v238, v239
    ds_write_b32 v1, v219 offset:23760
    v_pk_mul_f32 v[226:227], v[234:235], v[222:223] op_sel:[0,0] op_sel_hi:[1,0]
    v_pk_fma_f32 v[226:227], v[234:235], v[222:223], v[226:227] op_sel:[1,1,0] op_sel_hi:[0,1,1] neg_lo:[1,0,0]
    v_cvt_pk_bf16_f32 v216, v224, v225
    ds_write_b32 v1, v216 offset:24288
    v_pk_mul_f32 v[228:229], v[236:237], v[222:223] op_sel:[0,0] op_sel_hi:[1,0]
    v_pk_fma_f32 v[228:229], v[236:237], v[222:223], v[228:229] op_sel:[1,1,0] op_sel_hi:[0,1,1] neg_lo:[1,0,0]
    v_cvt_pk_bf16_f32 v217, v226, v227
    ds_write_b32 v1, v217 offset:24816
    v_pk_mul_f32 v[230:231], v[238:239], v[222:223] op_sel:[0,0] op_sel_hi:[1,0]
    v_pk_fma_f32 v[230:231], v[238:239], v[222:223], v[230:231] op_sel:[1,1,0] op_sel_hi:[0,1,1] neg_lo:[1,0,0]
    v_cvt_pk_bf16_f32 v218, v228, v229
    ds_write_b32 v1, v218 offset:25344
    v_pk_mul_f32 v[232:233], v[224:225], v[222:223] op_sel:[0,0] op_sel_hi:[1,0]
    v_pk_fma_f32 v[232:233], v[224:225], v[222:223], v[232:233] op_sel:[1,1,0] op_sel_hi:[0,1,1] neg_lo:[1,0,0]
    v_cvt_pk_bf16_f32 v219, v230, v231
    ds_write_b32 v1, v219 offset:25872
    v_pk_mul_f32 v[234:235], v[226:227], v[222:223] op_sel:[0,0] op_sel_hi:[1,0]
    v_pk_fma_f32 v[234:235], v[226:227], v[222:223], v[234:235] op_sel:[1,1,0] op_sel_hi:[0,1,1] neg_lo:[1,0,0]
    v_cvt_pk_bf16_f32 v216, v232, v233
    ds_write_b32 v1, v216 offset:26400
    v_pk_mul_f32 v[236:237], v[228:229], v[222:223] op_sel:[0,0] op_sel_hi:[1,0]
    v_pk_fma_f32 v[236:237], v[228:229], v[222:223], v[236:237] op_sel:[1,1,0] op_sel_hi:[0,1,1] neg_lo:[1,0,0]
    v_cvt_pk_bf16_f32 v217, v234, v235
    ds_write_b32 v1, v217 offset:26928
    v_pk_mul_f32 v[238:239], v[230:231], v[222:223] op_sel:[0,0] op_sel_hi:[1,0]
    v_pk_fma_f32 v[238:239], v[230:231], v[222:223], v[238:239] op_sel:[1,1,0] op_sel_hi:[0,1,1] neg_lo:[1,0,0]
    v_cvt_pk_bf16_f32 v218, v236, v237
    ds_write_b32 v1, v218 offset:27456
    v_cvt_pk_bf16_f32 v219, v238, v239
    ds_write_b32 v1, v219 offset:27984
    s_branch Lkj
Lk1:
    v_mul_f32 v210, v214, v210
    v_mul_f32 v211, v214, v211
    v_xor_b32 v209, 0x80000000, v209
    v_mul_f32 v220, 0x3fb8aa3b, v208
    v_mul_f32 v221, 0x3e22f983, v209
    v_exp_f32 v220, v220
    v_fract_f32 v221, v221
    v_cos_f32 v222, v221
    v_sin_f32 v223, v221
    v_mul_f32 v222, v222, v220
    v_mul_f32 v223, v223, v220
    v_pk_mul_f32 v[230:231], v[212:213], v[210:211] op_sel:[0,0] op_sel_hi:[1,0]
    v_pk_fma_f32 v[230:231], v[212:213], v[210:211], v[230:231] op_sel:[1,1,0] op_sel_hi:[0,1,1] neg_lo:[1,0,0]
    v_mul_f32 v220, 0x43b8aa3b, v208
    v_mul_f32 v221, 0x4222f983, v209
    v_exp_f32 v220, v220
    v_fract_f32 v221, v221
    v_cos_f32 v228, v221
    v_sin_f32 v229, v221
    v_mul_f32 v228, v228, v220
    v_mul_f32 v229, v229, v220
    v_xor_b32 v231, 0x80000000, v231
    v_pk_mul_f32 v[224:225], v[222:223], v[222:223] op_sel:[0,0] op_sel_hi:[1,0]
    v_pk_fma_f32 v[224:225], v[222:223], v[222:223], v[224:225] op_sel:[1,1,0] op_sel_hi:[0,1,1] neg_lo:[1,0,0]
    v_pk_mul_f32 v[232:233], v[230:231], v[222:223] op_sel:[0,0] op_sel_hi:[1,0]
    v_pk_fma_f32 v[232:233], v[230:231], v[222:223], v[232:233] op_sel:[1,1,0] op_sel_hi:[0,1,1] neg_lo:[1,0,0]
    v_cvt_pk_bf16_f32 v216, v230, v231
    ds_write_b32 v1, v216 offset:0
    v_pk_mul_f32 v[226:227], v[224:225], v[224:225] op_sel:[0,0] op_sel_hi:[1,0]
    v_pk_fma_f32 v[226:227], v[224:225], v[224:225], v[226:227] op_sel:[1,1,0] op_sel_hi:[0,1,1] neg_lo:[1,0,0]
    v_pk_mul_f32 v[234:235], v[230:231], v[224:225] op_sel:[0,0] op_sel_hi:[1,0]
    v_pk_fma_f32 v[234:235], v[230:231], v[224:225], v[234:235] op_sel:[1,1,0] op_sel_hi:[0,1,1] neg_lo:[1,0,0]
    v_cvt_pk_bf16_f32 v217, v232, v233
    ds_write_b32 v1, v217 offset:528
    v_pk_mul_f32 v[236:237], v[232:233], v[224:225] op_sel:[0,0] op_sel_hi:[1,0]
    v_pk_fma_f32 v[236:237], v[232:233], v[224:225], v[236:237] op_sel:[1,1,0] op_sel_hi:[0,1,1] neg_lo:[1,0,0]
    v_cvt_pk_bf16_f32 v218, v234, v235
    ds_write_b32 v1, v218 offset:1056
    v_pk_mul_f32 v[238:239], v[230:231], v[226:227] op_sel:[0,0] op_sel_hi:[1,0]
    v_pk_fma_f32 v[238:239], v[230:231], v[226:227], v[238:239] op_sel:[1,1,0] op_sel_hi:[0,1,1] neg_lo:[1,0,0]
    v_cvt_pk_bf16_f32 v219, v236, v237
    ds_write_b32 v1, v219 offset:1584
    v_pk_mul_f32 v[240:241], v[232:233], v[226:227] op_sel:[0,0] op_sel_hi:[1,0]
    v_pk_fma_f32 v[240:241], v[232:233], v[226:227], v[240:241] op_sel:[1,1,0] op_sel_hi:[0,1,1] neg_lo:[1,0,0]
    v_cvt_pk_bf16_f32 v216, v238, v239
    ds_write_b32 v1, v216 offset:2112
    v_pk_mul_f32 v[242:243], v[234:235], v[226:227] op_sel:[0,0] op_sel_hi:[1,0]
    v_pk_fma_f32 v[242:243], v[234:235], v[226:227], v[242:243] op_sel:[1,1,0] op_sel_hi:[0,1,1] neg_lo:[1,0,0]
    v_cvt_pk_bf16_f32 v217, v240, v241
    ds_write_b32 v1, v217 offset:2640
    v_pk_mul_f32 v[244:245], v[236:237], v[226:227] op_sel:[0,0] op_sel_hi:[1,0]
    v_pk_fma_f32 v[244:245], v[236:237], v[226:227], v[244:245] op_sel:[1,1,0] op_sel_hi:[0,1,1] neg_lo:[1,0,0]
    v_cvt_pk_bf16_f32 v218, v242, v243
    ds_write_b32 v1, v218 offset:3168
    v_pk_mul_f32 v[246:247], v[230:231], v[228:229] op_sel:[0,0] op_sel_hi:[1,0]
    v_pk_fma_f32 v[246:247], v[230:231], v[228:229], v[246:247] op_sel:[1,1,0] op_sel_hi:[0,1,1] neg_lo:[1,0,0]
    v_cvt_pk_bf16_f32 v219, v244, v245
    ds_write_b32 v1, v219 offset:3696
    v_pk_mul_f32 v[248:249], v[234:235], v[228:229] op_sel:[0,0] op_sel_hi:[1,0]
    v_pk_fma_f32 v[248:249], v[234:235], v[228:229], v[248:249] op_sel:[1,1,0] op_sel_hi:[0,1,1] neg_lo:[1,0,0]
    v_cvt_pk_bf16_f32 v216, v246, v247
    ds_write_b32 v1, v216 offset:4224
    v_pk_mul_f32 v[250:251], v[238:239], v[228:229] op_sel:[0,0] op_sel_hi:[1,0]
    v_pk_fma_f32 v[250:251], v[238:239], v[228:229], v[250:251] op_sel:[1,1,0] op_sel_hi:[0,1,1] neg_lo:[1,0,0]
    v_cvt_pk_bf16_f32 v217, v248, v249
    ds_write_b32 v1, v217 offset:4752
    v_pk_mul_f32 v[252:253], v[242:243], v[228:229] op_sel:[0,0] op_sel_hi:[1,0]
    v_pk_fma_f32 v[252:253], v[242:243], v[228:229], v[252:253] op_sel:[1,1,0] op_sel_hi:[0,1,1] neg_lo:[1,0,0]
    v_cvt_pk_bf16_f32 v218, v250, v251
    ds_write_b32 v1, v218 offset:5280
    v_pk_mul_f32 v[254:255], v[246:247], v[228:229] op_sel:[0,0] op_sel_hi:[1,0]
    v_pk_fma_f32 v[254:255], v[246:247], v[228:229], v[254:255] op_sel:[1,1,0] op_sel_hi:[0,1,1] neg_lo:[1,0,0]
    v_cvt_pk_bf16_f32 v219, v252, v253
    ds_write_b32 v1, v219 offset:5808
    v_pk_mul_f32 v[222:223], v[250:251], v[228:229] op_sel:[0,0] op_sel_hi:[1,0]
    v_pk_fma_f32 v[222:223], v[250:251], v[228:229], v[222:223] op_sel:[1,1,0] op_sel_hi:[0,1,1] neg_lo:[1,0,0]
    v_cvt_pk_bf16_f32 v216, v254, v255
    ds_write_b32 v1, v216 offset:6336
    v_pk_mul_f32 v[230:231], v[254:255], v[228:229] op_sel:[0,0] op_sel_hi:[1,0]
    v_pk_fma_f32 v[230:231], v[254:255], v[228:229], v[230:231] op_sel:[1,1,0] op_sel_hi:[0,1,1] neg_lo:[1,0,0]
    v_cvt_pk_bf16_f32 v217, v222, v223
    ds_write_b32 v1, v217 offset:10560
    v_pk_mul_f32 v[224:225], v[222:223], v[228:229] op_sel:[0,0] op_sel_hi:[1,0]
    v_pk_fma_f32 v[224:225], v[222:223], v[228:229], v[224:225] op_sel:[1,1,0] op_sel_hi:[0,1,1] neg_lo:[1,0,0]
    v_cvt_pk_bf16_f32 v218, v230, v231
    ds_write_b32 v1, v218 offset:6864
    v_pk_mul_f32 v[232:233], v[230:231], v[228:229] op_sel:[0,0] op_sel_hi:[1,0]
    v_pk_fma_f32 v[232:233], v[230:231], v[228:229], v[232:233] op_sel:[1,1,0] op_sel_hi:[0,1,1] neg_lo:[1,0,0]
    v_cvt_pk_bf16_f32 v219, v224, v225
    ds_write_b32 v1, v219 offset:11088
    v_pk_mul_f32 v[234:235], v[232:233], v[228:229] op_sel:[0,0] op_sel_hi:[1,0]
    v_pk_fma_f32 v[234:235], v[232:233], v[228:229], v[234:235] op_sel:[1,1,0] op_sel_hi:[0,1,1] neg_lo:[1,0,0]
    v_cvt_pk_bf16_f32 v216, v232, v233
    ds_write_b32 v1, v216 offset:7392
    v_pk_mul_f32 v[236:237], v[234:235], v[228:229] op_sel:[0,0] op_sel_hi:[1,0]
    v_pk_fma_f32 v[236:237], v[234:235], v[228:229], v[236:237] op_sel:[1,1,0] op_sel_hi:[0,1,1] neg_lo:[1,0,0]
    v_cvt_pk_bf16_f32 v217, v234, v235
    ds_write_b32 v1, v217 offset:7920
    v_pk_mul_f32 v[238:239], v[236:237], v[228:229] op_sel:[0,0] op_sel_hi:[1,0]
    v_pk_fma_f32 v[238:239], v[236:237], v[228:229], v[238:239] op_sel:[1,1,0] op_sel_hi:[0,1,1] neg_lo:[1,0,0]
    v_cvt_pk_bf16_f32 v218, v236, v237
    ds_write_b32 v1, v218 offset:8448
    v_pk_mul_f32 v[240:241], v[238:239], v[228:229] op_sel:[0,0] op_sel_hi:[1,0]
    v_pk_fma_f32 v[240:241], v[238:239], v[228:229], v[240:241] op_sel:[1,1,0] op_sel_hi:[0,1,1] neg_lo:[1,0,0]
    v_cvt_pk_bf16_f32 v219, v238, v239
    ds_write_b32 v1, v219 offset:8976
    v_cvt_pk_bf16_f32 v216, v240, v241
    ds_write_b32 v1, v216 offset:9504
Lkj:
    s_waitcnt vmcnt(0)
    s_waitcnt lgkmcnt(0)
    s_barrier
    ds_read_b128 v[224:227], v32 offset:0
    ds_read_b128 v[228:231], v33 offset:0
    s_cmp_lg_u32 s101, 0
    s_cbranch_scc1 Lo_2
    s_lshl_b32 s3, s48, 5
    s_add_u32 s3, s3, 458752
    v_mov_b32 v24, s100
    s_mov_b64 exec, 0x1111
    buffer_store_dword v24, v2, s[56:59], s3 offen sc1
    s_mov_b64 exec, -1
Lo_2:
    s_lshl_b32 s3, s68, 4
    s_lshr_b32 s93, s93, s3
    s_lshl_b32 s93, s93, 16
    s_cmp_lt_u32 s101, 2
    s_cselect_b32 s93, s93, 0
    v_mov_b32 v39, 0
    v_writelane_b32 v39, s93, 0
    s_mul_i32 s99, s67, 3072
    v_add_u32_sdwa v44, s99, v40 dst_sel:DWORD dst_unused:UNUSED_PAD src0_sel:DWORD src1_sel:WORD_0
    v_add_u32_sdwa v45, s99, v40 dst_sel:DWORD dst_unused:UNUSED_PAD src0_sel:DWORD src1_sel:WORD_1
    ds_read_b128 v[232:235], v32 offset:16
    ds_read_b128 v[236:239], v33 offset:16
    v_add_u32_sdwa v46, s99, v41 dst_sel:DWORD dst_unused:UNUSED_PAD src0_sel:DWORD src1_sel:WORD_0
    v_add_u32_sdwa v47, s99, v41 dst_sel:DWORD dst_unused:UNUSED_PAD src0_sel:DWORD src1_sel:WORD_1
    v_add_u32_sdwa v48, s99, v42 dst_sel:DWORD dst_unused:UNUSED_PAD src0_sel:DWORD src1_sel:WORD_0
    v_add_u32_sdwa v49, s99, v42 dst_sel:DWORD dst_unused:UNUSED_PAD src0_sel:DWORD src1_sel:WORD_1
    v_add_u32_sdwa v50, s99, v43 dst_sel:DWORD dst_unused:UNUSED_PAD src0_sel:DWORD src1_sel:WORD_0
    ds_read_b128 v[240:243], v32 offset:32
    ds_read_b128 v[244:247], v33 offset:32
    s_mul_i32 s3, s67, 15552
    s_add_u32 s3, s3, 115200
    v_add_u32_sdwa v51, s3, v43 dst_sel:DWORD dst_unused:UNUSED_PAD src0_sel:DWORD src1_sel:WORD_1
    s_mul_i32 s3, s67, 8448
    s_lshl_b32 s98, s90, 9
    s_add_u32 s3, s3, s98
    s_add_u32 s3, s3, 98304
    v_lshl_add_u32 v52, v0, 3, s3
    v_mov_b32 v54, 0
    ds_read_b128 v[248:251], v32 offset:48
    ds_read_b128 v[252:255], v33 offset:48
    v_mov_b32 v55, 0
    buffer_store_dwordx4 v[144:147], v2, s[56:59], s40 offen offset:0 sc1
    buffer_store_dwordx4 v[144:147], v2, s[56:59], s40 offen offset:1024 sc1
    ds_read_b128 v[192:195], v32 offset:64
    ds_read_b128 v[196:199], v33 offset:64
    buffer_store_dwordx4 v[144:147], v2, s[56:59], s40 offen offset:2048 sc1
    ds_read_b128 v[200:203], v32 offset:80
    ds_read_b128 v[204:207], v33 offset:80
    buffer_store_dwordx4 v[144:147], v2, s[56:59], s40 offen offset:3072 sc1
    s_add_u32 s40, s40, 4096
    buffer_store_dwordx4 v[144:147], v2, s[56:59], s40 offen offset:0 sc1
    ds_read_b128 v[208:211], v32 offset:96
    ds_read_b128 v[212:215], v33 offset:96
    buffer_store_dwordx4 v[144:147], v2, s[56:59], s40 offen offset:1024 sc1
    buffer_store_dwordx4 v[144:147], v2, s[56:59], s40 offen offset:2048 sc1
    ds_read_b128 v[216:219], v32 offset:112
    ds_read_b128 v[220:223], v33 offset:112
    buffer_store_dwordx4 v[144:147], v2, s[56:59], s40 offen offset:3072 sc1
    s_waitcnt lgkmcnt(14)
    v_mfma_f32_16x16x32_bf16 v[60:63], v[224:227], v[228:231], 0
    s_waitcnt lgkmcnt(12)
    v_mfma_f32_16x16x32_bf16 v[60:63], v[232:235], v[236:239], v[60:63]
    s_waitcnt lgkmcnt(10)
    v_mfma_f32_16x16x32_bf16 v[60:63], v[240:243], v[244:247], v[60:63]
    s_waitcnt lgkmcnt(8)
    v_mfma_f32_16x16x32_bf16 v[60:63], v[248:251], v[252:255], v[60:63]
    s_waitcnt lgkmcnt(6)
    v_mfma_f32_16x16x32_bf16 v[60:63], v[192:195], v[196:199], v[60:63]
    s_waitcnt lgkmcnt(4)
    v_mfma_f32_16x16x32_bf16 v[60:63], v[200:203], v[204:207], v[60:63]
    s_waitcnt lgkmcnt(2)
    v_mfma_f32_16x16x32_bf16 v[60:63], v[208:211], v[212:215], v[60:63]
    s_waitcnt lgkmcnt(0)
    v_mfma_f32_16x16x32_bf16 v[60:63], v[216:219], v[220:223], v[60:63]
    s_mul_i32 s3, s68, 3072
    s_lshr_b32 s98, s101, 1
    s_mul_i32 s98, s98, 768
    s_add_u32 m0, s3, s98
    s_nop 0
    ds_write_addtid_b32 v31 offset:16896
    s_add_u32 s40, s40, 4096
    buffer_store_dwordx4 v[144:147], v2, s[56:59], s40 offen offset:0 sc1
    buffer_store_dwordx4 v[144:147], v2, s[56:59], s40 offen offset:1024 sc1
    buffer_store_dwordx4 v[144:147], v2, s[56:59], s40 offen offset:2048 sc1
    buffer_store_dwordx4 v[144:147], v2, s[56:59], s40 offen offset:3072 sc1
    s_add_u32 s40, s40, 4096
    buffer_store_dwordx4 v[144:147], v2, s[56:59], s40 offen offset:0 sc1
    buffer_store_dwordx4 v[144:147], v2, s[56:59], s40 offen offset:1024 sc1
    buffer_store_dwordx4 v[144:147], v2, s[56:59], s41 offen offset:0 sc1
    v_add_f32 v60, v60, v39
    v_cvt_pk_bf16_f32 v62, v62, v63
    v_cvt_pk_bf16_f32 v60, v60, v61
    ds_write_addtid_b32 v62 offset:16640
    ds_write_addtid_b32 v60 offset:16384
    s_waitcnt lgkmcnt(0)
    s_barrier
    ds_read_u16 v44, v44 offset:16384
    ds_read_u16 v45, v45 offset:16384
    ds_read_u16 v46, v46 offset:16384
    ds_read_u16 v47, v47 offset:16384
    ds_read_u16 v48, v48 offset:16384
    ds_read_u16 v49, v49 offset:16384
    ds_read_u16 v50, v50 offset:16384
    ds_write_b64 v51, v[54:55]
    buffer_store_dwordx4 v[144:147], v2, s[56:59], s41 offen offset:1024 sc1
    buffer_store_dwordx4 v[144:147], v2, s[56:59], s41 offen offset:2048 sc1
    buffer_store_dwordx4 v[144:147], v2, s[56:59], s41 offen offset:3072 sc1
    s_add_u32 s41, s41, 4096
    buffer_store_dwordx4 v[144:147], v2, s[56:59], s41 offen offset:0 sc1
    buffer_store_dwordx4 v[144:147], v2, s[56:59], s41 offen offset:1024 sc1
    buffer_store_dwordx4 v[144:147], v2, s[56:59], s41 offen offset:2048 sc1
    buffer_store_dwordx4 v[144:147], v2, s[56:59], s41 offen offset:3072 sc1
    s_lshl_b32 s38, s101, 10
    s_add_u32 s38, s38, 458752
    s_load_dword s28, s[46:47], s38 offset:0
    s_load_dword s29, s[46:47], s38 offset:256
    s_load_dword s30, s[46:47], s38 offset:512
    s_load_dword s31, s[46:47], s38 offset:768
    s_waitcnt lgkmcnt(6)
    v_lshl_or_b32 v38, v45, 16, v44
    s_waitcnt lgkmcnt(4)
    v_lshl_or_b32 v39, v47, 16, v46
    ds_write_b64 v52, v[38:39] offset:6336
    v_lshl_or_b32 v36, v46, 16, v45
    s_waitcnt lgkmcnt(4)
    v_lshl_or_b32 v37, v48, 16, v47
    ds_write_b64 v52, v[36:37] offset:4224
    v_lshl_or_b32 v34, v47, 16, v46
    s_waitcnt lgkmcnt(4)
    v_lshl_or_b32 v35, v49, 16, v48
    ds_write_b64 v52, v[34:35] offset:2112
    v_lshl_or_b32 v32, v48, 16, v47
    s_waitcnt lgkmcnt(4)
    v_lshl_or_b32 v33, v50, 16, v49
    ds_write_b64 v52, v[32:33] offset:0
    s_waitcnt lgkmcnt(0)
    s_xor_b32 s28, s28, s100
    s_xor_b32 s29, s29, s100
    s_xor_b32 s30, s30, s100
    s_xor_b32 s31, s31, s100
    s_or_b32 s28, s28, s29
    s_or_b32 s28, s28, s30
    s_or_b32 s28, s28, s31
    s_cbranch_scc1 Lsl_5
Lok_3:
    s_min_u32 s38, s101, 6
    s_lshl3_add_u32 s38, s52, s38
    s_lshl_b32 s38, s38, 10
    s_add_u32 s38, s38, 467968
    s_load_dword s28, s[46:47], s38 offset:0
    s_load_dword s29, s[46:47], s38 offset:256
    s_load_dword s30, s[46:47], s38 offset:512
    s_load_dword s31, s[46:47], s38 offset:768
    v_lshrrev_b32 v3, 2, v0
    v_lshlrev_b32 v3, 14, v3
    v_and_b32 v24, 2, v0
    v_lshl_or_b32 v3, v24, 5, v3
    v_and_b32 v24, 1, v0
    v_lshl_or_b32 v3, v24, 4, v3
    s_lshl_b32 s3, s101, 18
    s_lshr_b32 s98, s50, 1
    s_lshl_b32 s98, s98, 7
    s_add_u32 s3, s3, s98
    s_and_b32 s98, s50, 1
    s_lshl_b32 s98, s98, 5
    s_add_u32 s3, s3, s98
    s_add_u32 s3, s3, 0x200000
    buffer_load_dwordx4 v[24:27], v3, s[56:59], s3 offen sc1
    s_and_b32 s68, s101, 1
    s_lshr_b32 s69, s101, 1
    s_xor_b32 s3, s69, 3
    s_sub_u32 s69, s69, 2
    s_cselect_b32 s69, s3, s69
    v_bfe_u32 v36, v0, 2, 2
    v_mul_u32_u24 v36, 2112, v36
    v_and_b32 v37, 3, v0
    v_lshl_add_u32 v36, v37, 3, v36
    s_mul_i32 s3, s68, 8448
    s_add_u32 s3, s3, 98304
    v_add_u32 v36, s3, v36
    v_and_b32 v37, 48, v0
    v_sub_u32 v18, v36, v37
    v_mad_u32_u24 v19, v37, 6, v36
    v_lshrrev_b32 v38, 5, v0
    v_and_b32 v39, 16, v0
    s_movk_i32 s3, 152
    v_mad_u32_u24 v21, v38, s3, v36
    v_lshrrev_b32 v40, 1, v39
    v_sub_u32 v21, v21, v40
    v_and_b32 v40, 15, v0
    v_lshl_add_u32 v1, v40, 5, v37
    s_mul_i32 s3, s68, 15552
    s_lshl_b32 s98, s69, 10
    s_add_u32 s3, s3, s98
    s_add_u32 s3, s3, 114192
    v_add_u32 v1, s3, v1
    s_mul_i32 s3, s68, 15552
    s_lshl_b32 s98, s69, 10
    s_add_u32 s3, s3, s98
    s_add_u32 s3, s3, 118336
    v_lshl_add_u32 v22, v40, 3, s3
    v_sub_u32 v22, v22, v39
    s_movk_i32 s3, 3096
    v_mad_u32_u24 v22, v38, s3, v22
    v_and_b32 v40, 31, v0
    s_mul_i32 s3, s68, 15552
    s_lshl_b32 s98, s69, 10
    s_add_u32 s3, s3, s98
    s_add_u32 s3, s3, 123512
    v_lshl_add_u32 v23, v40, 3, s3
    s_movk_i32 s3, 2064
    v_mad_u32_u24 v23, v38, s3, v23
    v_and_b32 v36, 1, v0
    v_mul_u32_u24 v36, 15544, v36
    v_lshl_add_u32 v3, v0, 3, v36
    s_lshl_b32 s3, s101, 9
    s_add_u32 s3, s3, 116240
    v_add_u32 v3, s3, v3
    s_waitcnt vmcnt(0)
    ds_write_b128 v3, v[24:27] offset:16
    s_waitcnt lgkmcnt(0)
    s_barrier
    s_cmp_ge_u32 s101, 6
    s_cbranch_scc1 Lo_6
    ds_read_b128 v[32:35], v3
    v_lshlrev_b32 v44, 16, v24
    v_and_b32 v45, 0xffff0000, v24
    v_lshlrev_b32 v46, 16, v25
    v_and_b32 v47, 0xffff0000, v25
    v_lshlrev_b32 v48, 16, v26
    v_and_b32 v49, 0xffff0000, v26
    s_waitcnt lgkmcnt(0)
    v_lshlrev_b32 v36, 16, v32
    v_and_b32 v37, 0xffff0000, v32
    v_lshlrev_b32 v38, 16, v33
    v_add_f32 v37, v37, v36
    v_and_b32 v39, 0xffff0000, v33
    v_add_f32 v38, v38, v37
    v_lshlrev_b32 v40, 16, v34
    v_add_f32 v39, v39, v38
    v_and_b32 v41, 0xffff0000, v34
    v_add_f32 v40, v40, v39
    v_lshlrev_b32 v42, 16, v35
    v_add_f32 v41, v41, v40
    v_and_b32 v43, 0xffff0000, v35
    v_add_f32 v42, v42, v41
    v_add_f32 v43, v43, v42
    v_add_f32 v44, v44, v43
    v_add_f32 v45, v45, v44
    v_add_f32 v46, v46, v45
    v_add_f32 v47, v47, v46
    v_add_f32 v48, v48, v47
    v_add_f32 v49, v49, v48
    v_sub_f32 v52, v41, v38
    v_sub_f32 v53, v42, v39
    v_sub_f32 v54, v43, v40
    v_sub_f32 v55, v44, v41
    v_sub_f32 v56, v45, v42
    v_sub_f32 v57, v46, v43
    v_sub_f32 v58, v47, v44
    v_sub_f32 v59, v48, v45
    v_cvt_pk_bf16_f32 v60, v52, v53
    v_cvt_pk_bf16_f32 v61, v54, v55
    v_cvt_pk_bf16_f32 v62, v56, v57
    v_cvt_pk_bf16_f32 v63, v58, v59
    ds_write_b128 v3, v[60:63] offset:4144
    v_sub_f32 v52, v42, v37
    v_sub_f32 v53, v43, v38
    v_sub_f32 v54, v44, v39
    v_sub_f32 v55, v45, v40
    v_sub_f32 v56, v46, v41
    v_sub_f32 v57, v47, v42
    v_sub_f32 v58, v48, v43
    v_sub_f32 v59, v49, v44
    v_cvt_pk_bf16_f32 v32, v52, v53
    v_cvt_pk_bf16_f32 v33, v54, v55
    v_cvt_pk_bf16_f32 v34, v56, v57
    v_cvt_pk_bf16_f32 v35, v58, v59
    ds_write_b128 v3, v[32:35] offset:7248
Lo_6:
    s_cmp_ge_u32 s101, 4
    s_cbranch_scc1 Lo_7
    v_lshlrev_b32 v50, 16, v27
    v_and_b32 v51, 0xffff0000, v27
    v_add_f32 v50, v50, v49
    v_add_f32 v51, v51, v50
    v_sub_f32 v52, v43, v36
    v_sub_f32 v53, v44, v37
    v_sub_f32 v54, v45, v38
    v_sub_f32 v55, v46, v39
    v_sub_f32 v56, v47, v40
    v_sub_f32 v57, v48, v41
    v_sub_f32 v58, v49, v42
    v_sub_f32 v59, v50, v43
    v_cvt_pk_bf16_f32 v60, v52, v53
    v_cvt_pk_bf16_f32 v61, v54, v55
    v_cvt_pk_bf16_f32 v62, v56, v57
    v_cvt_pk_bf16_f32 v63, v58, v59
    ds_write_b128 v3, v[60:63] offset:10352
    v_sub_f32 v53, v45, v36
    v_sub_f32 v54, v46, v37
    v_sub_f32 v55, v47, v38
    v_sub_f32 v56, v48, v39
    v_sub_f32 v57, v49, v40
    v_sub_f32 v58, v50, v41
    v_sub_f32 v59, v51, v42
    v_cvt_pk_bf16_f32 v32, v44, v53
    v_cvt_pk_bf16_f32 v33, v54, v55
    v_cvt_pk_bf16_f32 v34, v56, v57
    v_cvt_pk_bf16_f32 v35, v58, v59
    ds_write_b128 v3, v[32:35] offset:12432
Lo_7:
    s_xor_b32 s28, s28, s100
    s_xor_b32 s29, s29, s100
    s_xor_b32 s30, s30, s100
    s_xor_b32 s31, s31, s100
    s_or_b32 s28, s28, s29
    s_or_b32 s28, s28, s30
    s_or_b32 s28, s28, s31
    s_cbranch_scc1 Lsl_10
Lok_8:
    s_waitcnt lgkmcnt(0)
    s_barrier
    s_cmp_lg_u32 s101, 0
    s_cbranch_scc1 Lo_11
    s_lshl_b32 s3, s48, 5
    s_add_u32 s3, s3, 393216
    v_mov_b32 v36, s100
    s_mov_b64 exec, 0x1111
    buffer_store_dword v36, v2, s[56:59], s3 offen sc1
    s_mov_b64 exec, -1
Lo_11:
    buffer_load_dwordx4 v[128:131], v2, s[56:59], s65 offen offset:0 sc1
    buffer_load_dwordx4 v[132:135], v2, s[56:59], s65 offen offset:1024 sc1
    buffer_load_dwordx4 v[136:139], v2, s[56:59], s65 offen offset:2048 sc1
    buffer_load_dwordx4 v[140:143], v2, s[56:59], s65 offen offset:3072 sc1
    s_add_u32 s35, s65, 4096
    buffer_load_dwordx4 v[144:147], v2, s[56:59], s35 offen offset:0 sc1
    s_add_u32 s35, s65, 4096
    buffer_load_dwordx4 v[148:151], v2, s[56:59], s35 offen offset:1024 sc1
    s_add_u32 s35, s65, 4096
    buffer_load_dwordx4 v[152:155], v2, s[56:59], s35 offen offset:2048 sc1
    s_add_u32 s35, s65, 4096
    buffer_load_dwordx4 v[156:159], v2, s[56:59], s35 offen offset:3072 sc1
    s_add_u32 s35, s65, 8192
    buffer_load_dwordx4 v[160:163], v2, s[56:59], s35 offen offset:0 sc1
    s_add_u32 s35, s65, 8192
    buffer_load_dwordx4 v[164:167], v2, s[56:59], s35 offen offset:1024 sc1
    s_add_u32 s35, s65, 8192
    buffer_load_dwordx4 v[168:171], v2, s[56:59], s35 offen offset:2048 sc1
    s_add_u32 s35, s65, 8192
    buffer_load_dwordx4 v[172:175], v2, s[56:59], s35 offen offset:3072 sc1
    s_add_u32 s35, s65, 12288
    buffer_load_dwordx4 v[176:179], v2, s[56:59], s35 offen offset:0 sc1
    s_add_u32 s35, s65, 12288
    buffer_load_dwordx4 v[180:183], v2, s[56:59], s35 offen offset:1024 sc1
    s_add_u32 s35, s65, 114688
    buffer_load_dwordx4 v[184:187], v2, s[56:59], s35 offen offset:0 sc1
    s_add_u32 s35, s65, 114688
    buffer_load_dwordx4 v[188:191], v2, s[56:59], s35 offen offset:1024 sc1
    s_add_u32 s35, s65, 114688
    buffer_load_dwordx4 v[192:195], v2, s[56:59], s35 offen offset:2048 sc1
    s_add_u32 s35, s65, 114688
    buffer_load_dwordx4 v[196:199], v2, s[56:59], s35 offen offset:3072 sc1
    s_add_u32 s35, s65, 118784
    buffer_load_dwordx4 v[200:203], v2, s[56:59], s35 offen offset:0 sc1
    s_add_u32 s35, s65, 118784
    buffer_load_dwordx4 v[204:207], v2, s[56:59], s35 offen offset:1024 sc1
    s_add_u32 s35, s65, 118784
    buffer_load_dwordx4 v[208:211], v2, s[56:59], s35 offen offset:2048 sc1
    s_add_u32 s35, s65, 118784
    buffer_load_dwordx4 v[212:215], v2, s[56:59], s35 offen offset:3072 sc1
    s_add_u32 s35, s65, 122880
    buffer_load_dwordx4 v[216:219], v2, s[56:59], s35 offen offset:0 sc1
    s_add_u32 s35, s65, 122880
    buffer_load_dwordx4 v[220:223], v2, s[56:59], s35 offen offset:1024 sc1
    s_add_u32 s35, s65, 122880
    buffer_load_dwordx4 v[8:11], v2, s[56:59], s35 offen offset:2048 sc1
    s_add_u32 s35, s65, 122880
    buffer_load_dwordx4 v[24:27], v2, s[56:59], s35 offen offset:3072 sc1
    s_or_b32 s3, s2, s101
    s_cbranch_scc1 Lo_12
    v_and_b32 v3, 31, v0
    v_max_u32 v3, 4, v3
    v_and_or_b32 v3, v0, 32, v3
    v_lshlrev_b32 v3, 8, v3
    s_mov_b32 s98, 466944
    buffer_load_dword v4, v3, s[56:59], s98 offen sc1
    s_mov_b32 s98, 483328
    buffer_load_dword v5, v3, s[56:59], s98 offen sc1
    s_mov_b32 s98, 499712
    buffer_load_dword v6, v3, s[56:59], s98 offen sc1
    s_mov_b32 s98, 516096
    buffer_load_dword v7, v3, s[56:59], s98 offen sc1
    s_waitcnt vmcnt(3)
    v_xor_b32 v4, s100, v4
    s_waitcnt vmcnt(2)
    v_xor_b32 v5, s100, v5
    s_waitcnt vmcnt(1)
    v_xor_b32 v6, s100, v6
    s_waitcnt vmcnt(0)
    v_xor_b32 v7, s100, v7
    v_or3_b32 v4, v4, v5, v6
    v_or_b32 v4, v4, v7
    v_cmp_ne_u32 vcc, 0, v4
    s_nop 1
    s_cmp_eq_u64 vcc, 0
    s_cbranch_scc1 Lok_13
    s_movk_i32 s3, 20000
Lsp_14:
    s_sleep 4
    s_mov_b32 s98, 466944
    buffer_load_dword v4, v3, s[56:59], s98 offen sc1
    s_mov_b32 s98, 483328
    buffer_load_dword v5, v3, s[56:59], s98 offen sc1
    s_mov_b32 s98, 499712
    buffer_load_dword v6, v3, s[56:59], s98 offen sc1
    s_mov_b32 s98, 516096
    buffer_load_dword v7, v3, s[56:59], s98 offen sc1
    s_waitcnt vmcnt(0)
    v_xor_b32 v4, s100, v4
    v_xor_b32 v5, s100, v5
    v_xor_b32 v6, s100, v6
    v_xor_b32 v7, s100, v7
    v_or3_b32 v4, v4, v5, v6
    v_or_b32 v4, v4, v7
    v_cmp_ne_u32 vcc, 0, v4
    s_nop 1
    s_cmp_eq_u64 vcc, 0
    s_cbranch_scc1 Lok_13
    s_sub_u32 s3, s3, 1
    s_cbranch_scc0 Lsp_14
Lok_13:
    s_mov_b32 s3, 655360
    v_mov_b32 v4, s100
    s_mov_b64 exec, 0x1111
    buffer_store_dword v4, v2, s[56:59], s3 offen sc1
    s_mov_b64 exec, -1
Lo_12:
    s_lshr_b32 s3, s51, 1
    s_lshl_b32 s3, s3, 12
    s_add_u32 s3, s3, 262144
    s_mul_i32 s39, s101, 7
    s_add_u32 s40, s39, 6
    s_lshr_b32 s39, s39, 2
    s_lshr_b32 s40, s40, 2
    s_lshl_b32 s39, s39, 8
    s_lshl_b32 s40, s40, 8
    s_add_u32 s39, s39, s3
    s_add_u32 s40, s40, s3
    s_lshl_b32 s37, s51, 8
    s_lshr_b32 s38, s50, 3
    s_lshl_b32 s38, s38, 8
    s_lshl3_add_u32 s44, s52, s101
    s_lshr_b32 s44, s44, 1
    s_lshl_b32 s44, s44, 8
    s_mov_b32 s36, s37
    s_load_dword s28, s[46:47], s39 offset:0
    s_load_dword s29, s[46:47], s39 offset:256
    s_load_dword s30, s[46:47], s40 offset:0
    s_load_dword s31, s[46:47], s36 offset:393216
    s_load_dword s32, s[46:47], s37 offset:393216
    s_load_dword s33, s[46:47], s38 offset:393216
    s_load_dword s34, s[46:47], s44 offset:393216
    s_mul_i32 s53, s51, 229376
    s_mul_i32 s3, s101, 7168
    s_add_u32 s53, s53, s3
    s_add_u32 s53, s53, 4194304
    s_add_u32 s91, s91, 57344
    ds_read_b64_tr_b16 v[96:97], v18 offset:1080
    ds_read_b64_tr_b16 v[98:99], v18 offset:1072
    ds_read_b128 v[100:103], v1 offset:1008
    ds_read_b128 v[104:107], v1 offset:1520
    ds_read_b64_tr_b16 v[108:109], v18 offset:568
    ds_read_b64_tr_b16 v[110:111], v18 offset:560
    ds_read_b128 v[112:115], v1 offset:2032
    ds_read_b64_tr_b16 v[116:117], v18 offset:56
    ds_read_b64_tr_b16 v[118:119], v18 offset:48
    ds_read_b128 v[120:123], v1 offset:2544
    ds_read_b64_tr_b16 v[124:125], v18 offset:1016
    ds_read_b64_tr_b16 v[126:127], v18 offset:1008
    s_setprio 3
    s_branch Ljoin
Lsl_5:
    s_load_dword s28, s[46:47], s38 offset:64
    s_load_dword s29, s[46:47], s38 offset:320
    s_load_dword s30, s[46:47], s38 offset:576
    s_load_dword s31, s[46:47], s38 offset:832
    s_waitcnt lgkmcnt(0)
    s_xor_b32 s28, s28, s100
    s_xor_b32 s29, s29, s100
    s_xor_b32 s30, s30, s100
    s_xor_b32 s31, s31, s100
    s_or_b32 s28, s28, s29
    s_or_b32 s28, s28, s30
    s_or_b32 s28, s28, s31
    s_cbranch_scc0 Lok_3
    s_load_dword s28, s[46:47], s38 offset:128
    s_load_dword s29, s[46:47], s38 offset:384
    s_load_dword s30, s[46:47], s38 offset:640
    s_load_dword s31, s[46:47], s38 offset:896
    s_waitcnt lgkmcnt(0)
    s_xor_b32 s28, s28, s100
    s_xor_b32 s29, s29, s100
    s_xor_b32 s30, s30, s100
    s_xor_b32 s31, s31, s100
    s_or_b32 s28, s28, s29
    s_or_b32 s28, s28, s30
    s_or_b32 s28, s28, s31
    s_cbranch_scc0 Lok_3
    s_load_dword s28, s[46:47], s38 offset:192
    s_load_dword s29, s[46:47], s38 offset:448
    s_load_dword s30, s[46:47], s38 offset:704
    s_load_dword s31, s[46:47], s38 offset:960
    s_waitcnt lgkmcnt(0)
    s_xor_b32 s28, s28, s100
    s_xor_b32 s29, s29, s100
    s_xor_b32 s30, s30, s100
    s_xor_b32 s31, s31, s100
    s_or_b32 s28, s28, s29
    s_or_b32 s28, s28, s30
    s_or_b32 s28, s28, s31
    s_cbranch_scc0 Lok_3
    s_movk_i32 s3, 20000
Lsp_4:
    s_sleep 2
    s_add_u32 s28, s38, 0
    v_mov_b32 v3, s28
    s_add_u32 s28, s38, 256
    v_writelane_b32 v3, s28, 1
    s_add_u32 s28, s38, 512
    v_writelane_b32 v3, s28, 2
    s_add_u32 s28, s38, 768
    v_writelane_b32 v3, s28, 3
    buffer_load_dword v3, v3, s[56:59], 0 offen sc1
    s_waitcnt vmcnt(0)
    v_cmp_ne_u32 vcc, s100, v3
    s_nop 1
    s_cmp_eq_u64 vcc, 0
    s_cbranch_scc1 Lok_3
    s_sub_u32 s3, s3, 1
    s_cbranch_scc0 Lsp_4
    s_branch Lok_3
Lsl_10:
    s_load_dword s28, s[46:47], s38 offset:64
    s_load_dword s29, s[46:47], s38 offset:320
    s_load_dword s30, s[46:47], s38 offset:576
    s_load_dword s31, s[46:47], s38 offset:832
    s_waitcnt lgkmcnt(0)
    s_xor_b32 s28, s28, s100
    s_xor_b32 s29, s29, s100
    s_xor_b32 s30, s30, s100
    s_xor_b32 s31, s31, s100
    s_or_b32 s28, s28, s29
    s_or_b32 s28, s28, s30
    s_or_b32 s28, s28, s31
    s_cbranch_scc0 Lok_8
    s_load_dword s28, s[46:47], s38 offset:128
    s_load_dword s29, s[46:47], s38 offset:384
    s_load_dword s30, s[46:47], s38 offset:640
    s_load_dword s31, s[46:47], s38 offset:896
    s_waitcnt lgkmcnt(0)
    s_xor_b32 s28, s28, s100
    s_xor_b32 s29, s29, s100
    s_xor_b32 s30, s30, s100
    s_xor_b32 s31, s31, s100
    s_or_b32 s28, s28, s29
    s_or_b32 s28, s28, s30
    s_or_b32 s28, s28, s31
    s_cbranch_scc0 Lok_8
    s_load_dword s28, s[46:47], s38 offset:192
    s_load_dword s29, s[46:47], s38 offset:448
    s_load_dword s30, s[46:47], s38 offset:704
    s_load_dword s31, s[46:47], s38 offset:960
    s_waitcnt lgkmcnt(0)
    s_xor_b32 s28, s28, s100
    s_xor_b32 s29, s29, s100
    s_xor_b32 s30, s30, s100
    s_xor_b32 s31, s31, s100
    s_or_b32 s28, s28, s29
    s_or_b32 s28, s28, s30
    s_or_b32 s28, s28, s31
    s_cbranch_scc0 Lok_8
    s_movk_i32 s3, 20000
Lsp_9:
    s_sleep 2
    s_add_u32 s28, s38, 0
    v_mov_b32 v3, s28
    s_add_u32 s28, s38, 256
    v_writelane_b32 v3, s28, 1
    s_add_u32 s28, s38, 512
    v_writelane_b32 v3, s28, 2
    s_add_u32 s28, s38, 768
    v_writelane_b32 v3, s28, 3
    buffer_load_dword v3, v3, s[56:59], 0 offen sc1
    s_waitcnt vmcnt(0)
    v_cmp_ne_u32 vcc, s100, v3
    s_nop 1
    s_cmp_eq_u64 vcc, 0
    s_cbranch_scc1 Lok_8
    s_sub_u32 s3, s3, 1
    s_cbranch_scc0 Lsp_9
    s_branch Lok_8
Lsl_25:
    s_movk_i32 s28, 20000
Lsp_24:
    s_sleep 2
    v_and_b32 v20, 3, v0
    v_lshlrev_b32 v20, 8, v20
    buffer_load_dword v20, v20, s[56:59], s38 offen sc1
    s_waitcnt vmcnt(0)
    v_cmp_ne_u32 vcc, s100, v20
    s_nop 1
    s_cmp_eq_u64 vcc, 0
    s_cbranch_scc1 Lok_23
    s_sub_u32 s28, s28, 1
    s_cbranch_scc0 Lsp_24
    s_branch Lok_23
Lsl_28:
    s_load_dword s28, s[46:47], s38 offset:64
    s_load_dword s29, s[46:47], s38 offset:320
    s_load_dword s30, s[46:47], s38 offset:576
    s_load_dword s31, s[46:47], s38 offset:832
    s_waitcnt lgkmcnt(0)
    s_xor_b32 s28, s28, s100
    s_xor_b32 s29, s29, s100
    s_xor_b32 s30, s30, s100
    s_xor_b32 s31, s31, s100
    s_or_b32 s28, s28, s29
    s_or_b32 s28, s28, s30
    s_or_b32 s28, s28, s31
    s_cbranch_scc0 Lok_26
    s_load_dword s28, s[46:47], s38 offset:128
    s_load_dword s29, s[46:47], s38 offset:384
    s_load_dword s30, s[46:47], s38 offset:640
    s_load_dword s31, s[46:47], s38 offset:896
    s_waitcnt lgkmcnt(0)
    s_xor_b32 s28, s28, s100
    s_xor_b32 s29, s29, s100
    s_xor_b32 s30, s30, s100
    s_xor_b32 s31, s31, s100
    s_or_b32 s28, s28, s29
    s_or_b32 s28, s28, s30
    s_or_b32 s28, s28, s31
    s_cbranch_scc0 Lok_26
    s_load_dword s28, s[46:47], s38 offset:192
    s_load_dword s29, s[46:47], s38 offset:448
    s_load_dword s30, s[46:47], s38 offset:704
    s_load_dword s31, s[46:47], s38 offset:960
    s_waitcnt lgkmcnt(0)
    s_xor_b32 s28, s28, s100
    s_xor_b32 s29, s29, s100
    s_xor_b32 s30, s30, s100
    s_xor_b32 s31, s31, s100
    s_or_b32 s28, s28, s29
    s_or_b32 s28, s28, s30
    s_or_b32 s28, s28, s31
    s_cbranch_scc0 Lok_26
    s_movk_i32 s3, 20000
Lsp_27:
    s_sleep 2
    s_add_u32 s28, s38, 0
    v_mov_b32 v3, s28
    s_add_u32 s28, s38, 256
    v_writelane_b32 v3, s28, 1
    s_add_u32 s28, s38, 512
    v_writelane_b32 v3, s28, 2
    s_add_u32 s28, s38, 768
    v_writelane_b32 v3, s28, 3
    buffer_load_dword v3, v3, s[56:59], 0 offen sc1
    s_waitcnt vmcnt(0)
    v_cmp_ne_u32 vcc, s100, v3
    s_nop 1
    s_cmp_eq_u64 vcc, 0
    s_cbranch_scc1 Lok_26
    s_sub_u32 s3, s3, 1
    s_cbranch_scc0 Lsp_27
    s_branch Lok_26
Lsl_48:
    s_load_dword s28, s[46:47], s39 offset:64
    s_load_dword s29, s[46:47], s39 offset:320
    s_load_dword s30, s[46:47], s40 offset:64
    s_load_dword s31, s[46:47], s36 offset:393280
    s_load_dword s32, s[46:47], s37 offset:393280
    s_load_dword s33, s[46:47], s38 offset:393280
    s_load_dword s34, s[46:47], s44 offset:393280
    s_waitcnt lgkmcnt(0)
    s_xor_b32 s28, s28, s100
    s_xor_b32 s29, s29, s100
    s_xor_b32 s30, s30, s100
    s_xor_b32 s31, s31, s100
    s_xor_b32 s32, s32, s100
    s_xor_b32 s33, s33, s100
    s_xor_b32 s34, s34, s100
    s_or_b32 s28, s28, s29
    s_or_b32 s28, s28, s30
    s_or_b32 s28, s28, s31
    s_or_b32 s28, s28, s32
    s_or_b32 s28, s28, s33
    s_or_b32 s28, s28, s34
    s_cbranch_scc0 Lok_46
    s_load_dword s28, s[46:47], s39 offset:128
    s_load_dword s29, s[46:47], s39 offset:384
    s_load_dword s30, s[46:47], s40 offset:128
    s_load_dword s31, s[46:47], s36 offset:393344
    s_load_dword s32, s[46:47], s37 offset:393344
    s_load_dword s33, s[46:47], s38 offset:393344
    s_load_dword s34, s[46:47], s44 offset:393344
    s_waitcnt lgkmcnt(0)
    s_xor_b32 s28, s28, s100
    s_xor_b32 s29, s29, s100
    s_xor_b32 s30, s30, s100
    s_xor_b32 s31, s31, s100
    s_xor_b32 s32, s32, s100
    s_xor_b32 s33, s33, s100
    s_xor_b32 s34, s34, s100
    s_or_b32 s28, s28, s29
    s_or_b32 s28, s28, s30
    s_or_b32 s28, s28, s31
    s_or_b32 s28, s28, s32
    s_or_b32 s28, s28, s33
    s_or_b32 s28, s28, s34
    s_cbranch_scc0 Lok_46
    s_load_dword s28, s[46:47], s39 offset:192
    s_load_dword s29, s[46:47], s39 offset:448
    s_load_dword s30, s[46:47], s40 offset:192
    s_load_dword s31, s[46:47], s36 offset:393408
    s_load_dword s32, s[46:47], s37 offset:393408
    s_load_dword s33, s[46:47], s38 offset:393408
    s_load_dword s34, s[46:47], s44 offset:393408
    s_waitcnt lgkmcnt(0)
    s_xor_b32 s28, s28, s100
    s_xor_b32 s29, s29, s100
    s_xor_b32 s30, s30, s100
    s_xor_b32 s31, s31, s100
    s_xor_b32 s32, s32, s100
    s_xor_b32 s33, s33, s100
    s_xor_b32 s34, s34, s100
    s_or_b32 s28, s28, s29
    s_or_b32 s28, s28, s30
    s_or_b32 s28, s28, s31
    s_or_b32 s28, s28, s32
    s_or_b32 s28, s28, s33
    s_or_b32 s28, s28, s34
    s_cbranch_scc0 Lok_46
    s_movk_i32 s3, 20000
Lsp_47:
    s_sleep 2
    s_add_u32 s28, s39, 0
    v_mov_b32 v3, s28
    s_add_u32 s28, s39, 256
    v_writelane_b32 v3, s28, 1
    s_add_u32 s28, s40, 0
    v_writelane_b32 v3, s28, 2
    s_add_u32 s28, s36, 393216
    v_writelane_b32 v3, s28, 3
    s_add_u32 s28, s37, 393216
    v_writelane_b32 v3, s28, 4
    s_add_u32 s28, s38, 393216
    v_writelane_b32 v3, s28, 5
    s_add_u32 s28, s44, 393216
    v_writelane_b32 v3, s28, 6
    buffer_load_dword v3, v3, s[56:59], 0 offen sc1
    s_waitcnt vmcnt(0)
    v_cmp_ne_u32 vcc, s100, v3
    s_nop 1
    s_cmp_eq_u64 vcc, 0
    s_cbranch_scc1 Lok_46
    s_sub_u32 s3, s3, 1
    s_cbranch_scc0 Lsp_47
    s_branch Lok_46
Lsl_53:
    s_movk_i32 s28, 20000
Lsp_52:
    s_sub_u32 s28, s28, 1
    s_cbranch_scc1 Lok_51
    s_sleep 2
    v_min_u32 v13, 6, v0
    v_lshlrev_b32 v13, 10, v13
    s_add_u32 s3, s53, 172032
    buffer_load_dword v12, v13, s[56:59], s3 offen offset:1020 sc1
    s_waitcnt vmcnt(0)
    v_cmp_eq_u32 vcc, -1, v12
    s_nop 1
    s_cmp_eq_u64 vcc, 0
    s_cbranch_scc0 Lsp_52
    s_add_u32 s3, s53, 172032
    buffer_load_dwordx4 v[32:35], v2, s[56:59], s3 offen offset:0 sc1
    s_add_u32 s3, s53, 172032
    buffer_load_dwordx4 v[36:39], v2, s[56:59], s3 offen offset:1024 sc1
    s_add_u32 s3, s53, 172032
    buffer_load_dwordx4 v[40:43], v2, s[56:59], s3 offen offset:2048 sc1
    s_add_u32 s3, s53, 172032
    buffer_load_dwordx4 v[44:47], v2, s[56:59], s3 offen offset:3072 sc1
    s_add_u32 s3, s53, 176128
    buffer_load_dwordx4 v[48:51], v2, s[56:59], s3 offen offset:0 sc1
    s_add_u32 s3, s53, 176128
    buffer_load_dwordx4 v[52:55], v2, s[56:59], s3 offen offset:1024 sc1
    s_add_u32 s3, s53, 176128
    buffer_load_dwordx4 v[56:59], v2, s[56:59], s3 offen offset:2048 sc1
    s_waitcnt vmcnt(0)
    v_max_u32 v12, v32, v33
    v_max3_u32 v12, v12, v34, v35
    v_max3_u32 v12, v12, v36, v37
    v_max3_u32 v12, v12, v38, v39
    v_max3_u32 v12, v12, v40, v41
    v_max3_u32 v12, v12, v42, v43
    v_max3_u32 v12, v12, v44, v45
    v_max3_u32 v12, v12, v46, v47
    v_max3_u32 v12, v12, v48, v49
    v_max3_u32 v12, v12, v50, v51
    v_max3_u32 v12, v12, v52, v53
    v_max3_u32 v12, v12, v54, v55
    v_max3_u32 v12, v12, v56, v57
    v_max3_u32 v12, v12, v58, v59
    v_cmp_eq_u32 vcc, -1, v12
    s_nop 1
    s_cmp_eq_u64 vcc, 0
    s_cbranch_scc0 Lsp_52
    s_branch Lok_51
Lsl_56:
    s_mov_b32 s28, 400000
Lsp_55:
    s_sub_u32 s28, s28, 1
    s_cbranch_scc1 Lok_54
    ds_read_b32 v179, v31 offset:8
    s_waitcnt lgkmcnt(0)
    v_readfirstlane_b32 s3, v179
    s_cmp_eq_u32 s3, 8
    s_cbranch_scc0 Lsp_55
    s_branch Lok_54
Lsl_59:
    s_movk_i32 s28, 20000
Lsp_58:
    s_sub_u32 s28, s28, 1
    s_cbranch_scc1 Lok_57
    s_sleep 2
    v_min_u32 v13, 6, v0
    v_lshlrev_b32 v13, 10, v13
    s_add_u32 s3, s53, 57344
    buffer_load_dword v12, v13, s[56:59], s3 offen offset:1020 sc1
    s_waitcnt vmcnt(0)
    v_cmp_eq_u32 vcc, -1, v12
    s_nop 1
    s_cmp_eq_u64 vcc, 0
    s_cbranch_scc0 Lsp_58
    s_add_u32 s3, s53, 57344
    buffer_load_dwordx4 v[224:227], v2, s[56:59], s3 offen offset:0 sc1
    s_add_u32 s3, s53, 57344
    buffer_load_dwordx4 v[228:231], v2, s[56:59], s3 offen offset:1024 sc1
    s_add_u32 s3, s53, 57344
    buffer_load_dwordx4 v[232:235], v2, s[56:59], s3 offen offset:2048 sc1
    s_add_u32 s3, s53, 57344
    buffer_load_dwordx4 v[236:239], v2, s[56:59], s3 offen offset:3072 sc1
    s_add_u32 s3, s53, 61440
    buffer_load_dwordx4 v[240:243], v2, s[56:59], s3 offen offset:0 sc1
    s_add_u32 s3, s53, 61440
    buffer_load_dwordx4 v[244:247], v2, s[56:59], s3 offen offset:1024 sc1
    s_add_u32 s3, s53, 61440
    buffer_load_dwordx4 v[248:251], v2, s[56:59], s3 offen offset:2048 sc1
    s_waitcnt vmcnt(0)
    v_max_u32 v12, v224, v225
    v_max3_u32 v12, v12, v226, v227
    v_max3_u32 v12, v12, v228, v229
    v_max3_u32 v12, v12, v230, v231
    v_max3_u32 v12, v12, v232, v233
    v_max3_u32 v12, v12, v234, v235
    v_max3_u32 v12, v12, v236, v237
    v_max3_u32 v12, v12, v238, v239
    v_max3_u32 v12, v12, v240, v241
    v_max3_u32 v12, v12, v242, v243
    v_max3_u32 v12, v12, v244, v245
    v_max3_u32 v12, v12, v246, v247
    v_max3_u32 v12, v12, v248, v249
    v_max3_u32 v12, v12, v250, v251
    v_cmp_eq_u32 vcc, -1, v12
    s_nop 1
    s_cmp_eq_u64 vcc, 0
    s_cbranch_scc0 Lsp_58
    s_branch Lok_57
Lsl_62:
    s_movk_i32 s28, 20000
Lsp_61:
    s_sub_u32 s28, s28, 1
    s_cbranch_scc1 Lok_60
    s_mov_b32 m0, s45
    s_nop 0
    buffer_load_dwordx4 v29, s[56:59], s41 offen sc1 lds
    s_waitcnt vmcnt(0)
    ds_read_b64_tr_b16 v[128:129], v30
    ds_read_b64_tr_b16 v[130:131], v30 offset:512
    s_lshl_b32 m0, s101, 13
    s_waitcnt lgkmcnt(0)
    v_pk_max_u16 v12, v128, v129
    v_pk_max_u16 v13, v130, v131
    v_pk_max_u16 v12, v12, v13
    v_lshlrev_b32 v13, 16, v12
    v_max_u32 v12, v12, v13
    v_or_b32 v12, 0xffff, v12
    v_cmp_eq_u32 vcc, -1, v12
    s_nop 1
    s_cmp_eq_u64 vcc, 0
    s_cbranch_scc0 Lsp_61
    s_branch Lok_60
Lsl_67:
    s_mov_b32 s28, 400000
Lsp_66:
    s_sub_u32 s28, s28, 1
    s_cbranch_scc1 Lok_65
    ds_read_b32 v179, v31 offset:4
    s_waitcnt lgkmcnt(0)
    v_readfirstlane_b32 s3, v179
    s_cmp_eq_u32 s3, 8
    s_cbranch_scc0 Lsp_66
    s_branch Lok_65
parallel_sum__ssm_conv_s4__geglu_ffn__prompt_kernel_fin:
    s_endpgm
.p2align 7
parallel_sum__ssm_conv_s4__geglu_ffn__prompt_kernel_tab:
    .long 0x02000200, 0x02000200, 0x02000200, 0x00000200
    .long 0x02000200, 0x02000200, 0x02000200, 0x00080200
    .long 0x02000200, 0x02000200, 0x02000200, 0x00100200
    .long 0x02000200, 0x00000200, 0x01000002, 0x00180102
    .long 0x01000002, 0x00400102, 0x01400042, 0x00200142
    .long 0x01400042, 0x00040142, 0x01040006, 0x00280106
    .long 0x01040006, 0x00440106, 0x01440046, 0x00300146
    .long 0x01440046, 0x00080146, 0x0108000a, 0x0038010a
    .long 0x0108000a, 0x0048010a, 0x0148004a, 0x0040014a
    .long 0x0148004a, 0x000c014a, 0x010c000e, 0x0048010e
    .long 0x010c000e, 0x004c010e, 0x014c004e, 0x0050014e
    .long 0x014c004e, 0x0010014e, 0x01100012, 0x00580112
    .long 0x01100012, 0x00500112, 0x01500052, 0x00600152
    .long 0x01500052, 0x00140152, 0x01140016, 0x00680116
    .long 0x01140016, 0x00540116, 0x01540056, 0x00700156
    .long 0x01540056, 0x00180156, 0x0118001a, 0x0078011a
    .long 0x0118001a, 0x0058011a, 0x0158005a, 0x0080015a
    .long 0x0158005a, 0x001c015a, 0x011c001e, 0x0088011e
    .long 0x011c001e, 0x005c011e, 0x015c005e, 0x0090015e
    .long 0x015c005e, 0x0020015e, 0x01200022, 0x00980122
    .long 0x01200022, 0x00600122, 0x01600062, 0x00a00162
    .long 0x01600062, 0x00240162, 0x01240026, 0x00a80126
    .long 0x01240026, 0x00640126, 0x01640066, 0x00b00166
    .long 0x01640066, 0x00280166, 0x0128002a, 0x00b8012a
    .long 0x0128002a, 0x0068012a, 0x0168006a, 0x00c0016a
    .long 0x0168006a, 0x002c016a, 0x012c002e, 0x00c8012e
    .long 0x012c002e, 0x006c012e, 0x016c006e, 0x00d0016e
    .long 0x016c006e, 0x0030016e, 0x01300032, 0x00d80132
    .long 0x01300032, 0x00700132, 0x01700072, 0x00e00172
    .long 0x01700072, 0x00340172, 0x01340036, 0x00e80136
    .long 0x01340036, 0x00740136, 0x01740076, 0x00f00176
    .long 0x01740076, 0x00380176, 0x0138003a, 0x00f8013a
    .long 0x0138003a, 0x0078013a, 0x0178007a, 0x0100017a
    .long 0x0178007a, 0x003c017a, 0x013c003e, 0x0108013e
    .long 0x013c003e, 0x007c013e, 0x017c007e, 0x0110017e
    .long 0x017c007e, 0x0600017e, 0x07000602, 0x01180702
    .long 0x07000602, 0x06400702, 0x07400642, 0x01200742
    .long 0x07400642, 0x06040742, 0x07040606, 0x01280706
    .long 0x07040606, 0x06440706, 0x07440646, 0x01300746
    .long 0x07440646, 0x06080746, 0x0708060a, 0x0138070a
    .long 0x0708060a, 0x0648070a, 0x0748064a, 0x0140074a
    .long 0x0748064a, 0x060c074a, 0x070c060e, 0x0148070e
    .long 0x070c060e, 0x064c070e, 0x074c064e, 0x0150074e
    .long 0x074c064e, 0x0610074e, 0x07100612, 0x01580712
    .long 0x07100612, 0x06500712, 0x07500652, 0x01600752
    .long 0x07500652, 0x06140752, 0x07140616, 0x01680716
    .long 0x07140616, 0x06540716, 0x07540656, 0x01700756
    .long 0x07540656, 0x06180756, 0x0718061a, 0x0178071a
    .long 0x0718061a, 0x0658071a, 0x0758065a, 0x0180075a
    .long 0x0758065a, 0x061c075a, 0x071c061e, 0x0188071e
    .long 0x071c061e, 0x065c071e, 0x075c065e, 0x0190075e
    .long 0x075c065e, 0x0620075e, 0x07200622, 0x01980722
    .long 0x07200622, 0x06600722, 0x07600662, 0x01a00762
    .long 0x07600662, 0x06240762, 0x07240626, 0x01a80726
    .long 0x07240626, 0x06640726, 0x07640666, 0x01b00766
    .long 0x07640666, 0x06280766, 0x0728062a, 0x01b8072a
    .long 0x0728062a, 0x0668072a, 0x0768066a, 0x01c0076a
    .long 0x0768066a, 0x062c076a, 0x072c062e, 0x01c8072e
    .long 0x072c062e, 0x066c072e, 0x076c066e, 0x01d0076e
    .long 0x076c066e, 0x0630076e, 0x07300632, 0x01d80732
    .long 0x07300632, 0x06700732, 0x07700672, 0x01e00772
    .long 0x07700672, 0x06340772, 0x07340636, 0x01e80736
    .long 0x07340636, 0x06740736, 0x07740676, 0x01f00776
    .long 0x07740676, 0x06380776, 0x0738063a, 0x01f8073a
    .long 0x0738063a, 0x0678073a, 0x0778067a, 0x0200077a
    .long 0x0778067a, 0x063c077a, 0x073c063e, 0x0208073e
    .long 0x073c063e, 0x067c073e, 0x077c067e, 0x0210077e
    .long 0x077c067e, 0x0080077e, 0x00820080, 0x02180180
    .long 0x00820080, 0x01800180, 0x01820180, 0x02200084
    .long 0x01820180, 0x00840084, 0x00860084, 0x02280184
    .long 0x00860084, 0x01840184, 0x01860184, 0x02300088
    .long 0x01860184, 0x00880088, 0x008a0088, 0x02380188
    .long 0x008a0088, 0x01880188, 0x018a0188, 0x0240008c
    .long 0x018a0188, 0x008c008c, 0x008e008c, 0x0248018c
    .long 0x008e008c, 0x018c018c, 0x018e018c, 0x02500090
    .long 0x018e018c, 0x00900090, 0x00920090, 0x02580190
    .long 0x00920090, 0x01900190, 0x01920190, 0x02600094
    .long 0x01920190, 0x00940094, 0x00960094, 0x02680194
    .long 0x00960094, 0x01940194, 0x01960194, 0x02700098
    .long 0x01960194, 0x00980098, 0x009a0098, 0x02780198
    .long 0x009a0098, 0x01980198, 0x019a0198, 0x0280009c
    .long 0x019a0198, 0x009c009c, 0x009e009c, 0x0288019c
    .long 0x009e009c, 0x019c019c, 0x019e019c, 0x029000a0
    .long 0x019e019c, 0x00a000a0, 0x00a200a0, 0x029801a0
    .long 0x00a200a0, 0x01a001a0, 0x01a201a0, 0x02a000a4
    .long 0x01a201a0, 0x00a400a4, 0x00a600a4, 0x02a801a4
    .long 0x00a600a4, 0x01a401a4, 0x01a601a4, 0x02b000a8
    .long 0x01a601a4, 0x00a800a8, 0x00aa00a8, 0x02b801a8
    .long 0x00aa00a8, 0x01a801a8, 0x01aa01a8, 0x02c000ac
    .long 0x01aa01a8, 0x00ac00ac, 0x00ae00ac, 0x02c801ac
    .long 0x00ae00ac, 0x01ac01ac, 0x01ae01ac, 0x02d000b0
    .long 0x01ae01ac, 0x00b000b0, 0x00b200b0, 0x02d801b0
    .long 0x00b200b0, 0x01b001b0, 0x01b201b0, 0x02e000b4
    .long 0x01b201b0, 0x00b400b4, 0x00b600b4, 0x02e801b4
    .long 0x00b600b4, 0x01b401b4, 0x01b601b4, 0x02f000b8
    .long 0x01b601b4, 0x00b800b8, 0x00ba00b8, 0x02f801b8
    .long 0x00ba00b8, 0x01b801b8, 0x01ba01b8, 0x030000bc
    .long 0x01ba01b8, 0x00bc00bc, 0x00be00bc, 0x030801bc
    .long 0x00be00bc, 0x01bc01bc, 0x01be01bc, 0x03100680
    .long 0x01be01bc, 0x06800680, 0x06820680, 0x03180780
    .long 0x06820680, 0x07800780, 0x07820780, 0x03200684
    .long 0x07820780, 0x06840684, 0x06860684, 0x03280784
    .long 0x06860684, 0x07840784, 0x07860784, 0x03300688
    .long 0x07860784, 0x06880688, 0x068a0688, 0x03380788
    .long 0x068a0688, 0x07880788, 0x078a0788, 0x0340068c
    .long 0x078a0788, 0x068c068c, 0x068e068c, 0x0348078c
    .long 0x068e068c, 0x078c078c, 0x078e078c, 0x03500690
    .long 0x078e078c, 0x06900690, 0x06920690, 0x03580790
    .long 0x06920690, 0x07900790, 0x07920790, 0x03600694
    .long 0x07920790, 0x06940694, 0x06960694, 0x03680794
    .long 0x06960694, 0x07940794, 0x07960794, 0x03700698
    .long 0x07960794, 0x06980698, 0x069a0698, 0x03780798
    .long 0x069a0698, 0x07980798, 0x079a0798, 0x0380069c
    .long 0x079a0798, 0x069c069c, 0x069e069c, 0x0388079c
    .long 0x069e069c, 0x079c079c, 0x079e079c, 0x039006a0
    .long 0x079e079c, 0x06a006a0, 0x06a206a0, 0x039807a0
    .long 0x06a206a0, 0x07a007a0, 0x07a207a0, 0x03a006a4
    .long 0x07a207a0, 0x06a406a4, 0x06a606a4, 0x03a807a4
    .long 0x06a606a4, 0x07a407a4, 0x07a607a4, 0x03b006a8
    .long 0x07a607a4, 0x06a806a8, 0x06aa06a8, 0x03b807a8
    .long 0x06aa06a8, 0x07a807a8, 0x07aa07a8, 0x03c006ac
    .long 0x07aa07a8, 0x06ac06ac, 0x06ae06ac, 0x03c807ac
    .long 0x06ae06ac, 0x07ac07ac, 0x07ae07ac, 0x03d006b0
    .long 0x07ae07ac, 0x06b006b0, 0x06b206b0, 0x03d807b0
    .long 0x06b206b0, 0x07b007b0, 0x07b207b0, 0x03e006b4
    .long 0x07b207b0, 0x06b406b4, 0x06b606b4, 0x03e807b4
    .long 0x06b606b4, 0x07b407b4, 0x07b607b4, 0x03f006b8
    .long 0x07b607b4, 0x06b806b8, 0x06ba06b8, 0x03f807b8
    .long 0x06ba06b8, 0x07b807b8, 0x07ba07b8, 0x040006bc
    .long 0x07ba07b8, 0x06bc06bc, 0x06be06bc, 0x040807bc
    .long 0x06be06bc, 0x07bc07bc, 0x07be07bc, 0x041000c0
    .long 0x07be07bc, 0x00c000c0, 0x00c000c0, 0x04180200
    .long 0x00c000c0, 0x02000200, 0x02000200, 0x14200200
    .long 0x02000200, 0x02000200, 0x02000200, 0x14280200
    .long 0x02000200, 0x02000200, 0x02000200, 0x14300200
    .long 0x02000200, 0x02000200, 0x02000200, 0x14380200
    .long 0x02000200, 0x02000200, 0x02000200, 0x20400200
    .long 0x02000200, 0x02000200, 0x02000200, 0x20480200
    .long 0x02000200, 0x02000200, 0x02000200, 0x20500200
    .long 0x02000200, 0x02000200, 0x01c00200, 0x205801c0
    .long 0x01c00200, 0x01c001c0, 0x01c001c0, 0x2c6001c0
    .long 0x01c001c0, 0x01c001c0, 0x02000200, 0x2c680200
    .long 0x02000200, 0x02000200, 0x02000200, 0x2c700200
    .long 0x02000200, 0x02000200, 0x02000200, 0x2c780200
    .long 0x02000200, 0x02000200, 0x02000200, 0x34800200
    .long 0x02000200, 0x02000200, 0x02000200, 0x34880200
    .long 0x02000200, 0x03400200, 0x03500348, 0x34900358
    .long 0x03500348, 0x03600358, 0x03700368, 0x34980378
    .long 0x03700368, 0x09400378, 0x09500948, 0x3ca00958
    .long 0x09500948, 0x09600958, 0x09700968, 0x3ca80978
    .long 0x09700968, 0x03420978, 0x0352034a, 0x3cb0035a
    .long 0x0352034a, 0x0362035a, 0x0372036a, 0x3cb8037a
    .long 0x0372036a, 0x0942037a, 0x0952094a, 0x00c0095a
    .long 0x0952094a, 0x0962095a, 0x0972096a, 0x00c8097a
    .long 0x0972096a, 0x0200097a, 0x02000200, 0x00d00200
    .long 0x02000200, 0x02000200, 0x02000200, 0x00d80200
    .long 0x02000200, 0x02000200, 0x02000200, 0x00e00200
    .long 0x02000200, 0x02000200, 0x02000200, 0x00e80200
    .long 0x02000200, 0x03440200, 0x0354034c, 0x00f0035c
    .long 0x0354034c, 0x0364035c, 0x0374036c, 0x00f8037c
    .long 0x0374036c, 0x0944037c, 0x0954094c, 0x0100095c
    .long 0x0954094c, 0x0964095c, 0x0974096c, 0x0108097c
    .long 0x0974096c, 0x0346097c, 0x0356034e, 0x0110035e
    .long 0x0356034e, 0x0366035e, 0x0376036e, 0x0118037e
    .long 0x0376036e, 0x0946037e, 0x0956094e, 0x0120095e
    .long 0x0956094e, 0x0966095e, 0x0976096e, 0x0128097e
    .long 0x0976096e, 0x0200097e, 0x02000200, 0x01300200
    .long 0x02000200, 0x02000200, 0x02000200, 0x01380200
    .long 0x02000200, 0x02000200, 0x02000200, 0x01400200
    .long 0x02000200, 0x02000200, 0x02000200, 0x01480200
    .long 0x02000200, 0x00c40200, 0x00d400cc, 0x015000dc
    .long 0x00d400cc, 0x00e400dc, 0x00f400ec, 0x015800fc
    .long 0x00f400ec, 0x06c400fc, 0x06d406cc, 0x016006dc
    .long 0x06d406cc, 0x06e406dc, 0x06f406ec, 0x016806fc
    .long 0x06f406ec, 0x00c606fc, 0x00d600ce, 0x017000de
    .long 0x00d600ce, 0x00e600de, 0x00f600ee, 0x017800fe
    .long 0x00f600ee, 0x06c600fe, 0x06d606ce, 0x018006de
    .long 0x06d606ce, 0x06e606de, 0x06f606ee, 0x018806fe
    .long 0x06f606ee, 0x020006fe, 0x02000200, 0x01900200
    .long 0x02000200, 0x02000200, 0x02000200, 0x01980200
    .long 0x02000200, 0x02000200, 0x02000200, 0x01a00200
    .long 0x02000200, 0x02000200, 0x02000200, 0x01a80200
    .long 0x02000200, 0x00c80200, 0x00d800d0, 0x01b000e0
    .long 0x00d800d0, 0x00e800e0, 0x00f800f0, 0x01b806c0
    .long 0x00f800f0, 0x06c806c0, 0x06d806d0, 0x01c006e0
    .long 0x06d806d0, 0x06e806e0, 0x06f806f0, 0x01c800c2
    .long 0x06f806f0, 0x00ca00c2, 0x00da00d2, 0x01d000e2
    .long 0x00da00d2, 0x00ea00e2, 0x00fa00f2, 0x01d806c2
    .long 0x00fa00f2, 0x06ca06c2, 0x06da06d2, 0x01e006e2
    .long 0x06da06d2, 0x06ea06e2, 0x06fa06f2, 0x01e80200
    .long 0x06fa06f2, 0x02000200, 0x02000200, 0x01f00200
    .long 0x02000200, 0x02000200, 0x02000200, 0x01f80200
    .long 0x02000200, 0x02000200, 0x02000200, 0x02000200
    .long 0x02000200, 0x02000200, 0x02000200, 0x02080200
    .long 0x02000200, 0x01c40200, 0x01d401cc, 0x021001dc
    .long 0x01d401cc, 0x01e401dc, 0x01f401ec, 0x021801fc
    .long 0x01f401ec, 0x07c401fc, 0x07d407cc, 0x022007dc
    .long 0x07d407cc, 0x07e407dc, 0x07f407ec, 0x022807fc
    .long 0x07f407ec, 0x01c607fc, 0x01d601ce, 0x023001de
    .long 0x01d601ce, 0x01e601de, 0x01f601ee, 0x023801fe
    .long 0x01f601ee, 0x07c601fe, 0x07d607ce, 0x024007de
    .long 0x07d607ce, 0x07e607de, 0x07f607ee, 0x024807fe
    .long 0x07f607ee, 0x030407fe, 0x0314030c, 0x0250031c
    .long 0x0314030c, 0x0324031c, 0x0334032c, 0x0258033c
    .long 0x0334032c, 0x0904033c, 0x0914090c, 0x0260091c
    .long 0x0914090c, 0x0924091c, 0x0934092c, 0x0268093c
    .long 0x0934092c, 0x0306093c, 0x0316030e, 0x0270031e
    .long 0x0316030e, 0x0326031e, 0x0336032e, 0x0278033e
    .long 0x0336032e, 0x0906033e, 0x0916090e, 0x0280091e
    .long 0x0916090e, 0x0926091e, 0x0936092e, 0x0288093e
    .long 0x02000200, 0x02000200, 0x02000200, 0x02900200
    .long 0x02000200, 0x02000200, 0x02000200, 0x02980200
    .long 0x02000200, 0x02000200, 0x02000200, 0x02a00200
    .long 0x02000200, 0x01c80200, 0x01d801d0, 0x02a801e0
    .long 0x01d801d0, 0x01e801e0, 0x01f801f0, 0x02b007c0
    .long 0x01f801f0, 0x07c807c0, 0x07d807d0, 0x02b807e0
    .long 0x07d807d0, 0x07e807e0, 0x07f807f0, 0x02c001c2
    .long 0x07f807f0, 0x01ca01c2, 0x01da01d2, 0x02c801e2
    .long 0x01da01d2, 0x01ea01e2, 0x01fa01f2, 0x02d007c2
    .long 0x01fa01f2, 0x07ca07c2, 0x07da07d2, 0x02d807e2
    .long 0x07da07d2, 0x07ea07e2, 0x07fa07f2, 0x02e00300
    .long 0x07fa07f2, 0x03080300, 0x03180310, 0x02e80320
    .long 0x03180310, 0x03280320, 0x03380330, 0x02f00900
    .long 0x03380330, 0x09080900, 0x09180910, 0x02f80920
    .long 0x09180910, 0x09280920, 0x09380930, 0x03000302
    .long 0x09380930, 0x030a0302, 0x031a0312, 0x03080322
    .long 0x031a0312, 0x032a0322, 0x033a0332, 0x03100902
    .long 0x033a0332, 0x090a0902, 0x091a0912, 0x03180922
    .long 0x091a0912, 0x092a0922, 0x093a0932, 0x03200400
    .long 0x02000200, 0x02000200, 0x02000200, 0x03280200
    .long 0x02000200, 0x02000200, 0x02000200, 0x03300200
    .long 0x02000200, 0x02000200, 0x02000200, 0x03380200
    .long 0x02000200, 0x02000200, 0x02000200, 0x03400200
    .long 0x02000200, 0x02000200, 0x02000200, 0x03480200
    .long 0x02000200, 0x02000200, 0x02000200, 0x03500200
    .long 0x02000200, 0x02000200, 0x02000200, 0x03580200
    .long 0x02000200, 0x02000200, 0x02000200, 0x03600200
    .long 0x02000200, 0x02000200, 0x02000200, 0x03680200
    .long 0x02000200, 0x02000200, 0x02000200, 0x03700200
    .long 0x02000200, 0x02000200, 0x02000200, 0x03780200
    .long 0x02000200, 0x02000200, 0x02000200, 0x03800200
    .long 0x02000200, 0x02000200, 0x02000200, 0x03880200
    .long 0x02000200, 0x02000200, 0x02000200, 0x03900200
    .long 0x02000200, 0x02000200, 0x02000200, 0x03980200
    .long 0x02000200, 0x02000200, 0x02000200, 0x03a00200
    .long 0x02000200, 0x02000200, 0x02000200, 0x03a80200
    .long 0x02000200, 0x02000200, 0x02000200, 0x03b00200
    .long 0x02000200, 0x02000200, 0x02000200, 0x03b80200
    .long 0x02000200, 0x02000200, 0x02000200, 0x03c00200
    .long 0x02000200, 0x02000200, 0x02000200, 0x03c80200
    .long 0x02000200, 0x02000200, 0x02000200, 0x03d00200
    .long 0x02000200, 0x02000200, 0x02000200, 0x03d80200
    .long 0x02000200, 0x02000200, 0x02000200, 0x03e00200
    .long 0x02000200, 0x02000200, 0x02000200, 0x03e80200
    .long 0x02000200, 0x02000200, 0x02000200, 0x03f00200
    .long 0x02000200, 0x02000200, 0x02000200, 0x03f80200
.section .rodata,"a"
.p2align 6
.amdhsa_kernel parallel_sum__ssm_conv_s4__geglu_ffn__prompt_kernel
  .amdhsa_next_free_vgpr 256
  .amdhsa_next_free_sgpr 102
  .amdhsa_accum_offset 256
  .amdhsa_group_segment_fixed_size 0
  .amdhsa_kernarg_size 128
  .amdhsa_user_sgpr_count 2
  .amdhsa_user_sgpr_kernarg_segment_ptr 1
  .amdhsa_system_sgpr_workgroup_id_x 1
.end_amdhsa_kernel
```
